```python
import torch

def _softmax(x, axis=-1):
    return torch.softmax(x, dim=axis)
def _gelu(x):
    return torch.nn.functional.gelu(x, approximate="tanh")
def _silu(x):
    return torch.nn.functional.silu(x)
def _sigmoid(x):
    return torch.sigmoid(x)
def _layernorm(x, axis=-1, eps=1e-5):
    m = x.mean(dim=axis, keepdim=True)
    v = x.var(dim=axis, keepdim=True, unbiased=False)
    return (x - m) / torch.sqrt(v + eps)
def _scatter_add(tgt, idx, src, axis=0):
    return tgt.clone().index_add_(axis, idx, src)
def _segment_sum(src, seg, n):
    out = torch.zeros((n,) + src.shape[1:], dtype=src.dtype)
    return out.index_add_(0, seg, src)
def _pad(x, pw):
    flat = tuple(v for pair in reversed(pw) for v in pair)
    return torch.nn.functional.pad(x, flat)

kernel_name = 'recurrent_scan__ssm_conv_s4d__dense_activation_relu__prompt'

def setup_inputs():

    _w = (lambda a: (lambda t: t.to(torch.bfloat16) if t.is_floating_point() else t)(torch.as_tensor(a)))
    def _A_setup():
        Bsz, L, D, N = 1, 2048, 448, 256
        return {
            "u": _w((lambda *s: torch.randn(*s, dtype=torch.bfloat16) * 0.05)(Bsz, L, D)),
            "log_A_real": _w((lambda *s: torch.randn(*s, dtype=torch.bfloat16) * 6.4)(D, N) * 0.5),
            "A_imag": _w((lambda *s: torch.randn(*s, dtype=torch.bfloat16) * 0.05)(D, N) * 3.14),
            "C_real": _w((lambda *s: torch.randn(*s, dtype=torch.bfloat16) * 0.05)(D, N) / N ** 0.5),
            "C_imag": _w((lambda *s: torch.randn(*s, dtype=torch.bfloat16) * 0.05)(D, N) / N ** 0.5),
            "log_dt": _w((lambda *s: torch.randn(*s, dtype=torch.bfloat16) * 0.05)(D) * 0.5 - 4.0),
            "D_skip": _w((lambda *s: torch.randn(*s, dtype=torch.bfloat16) * 0.05)(D)),
        }
    _A_in = _A_setup()

    def _B_setup():
        B, S, D, Dff = 1, 2048, 448, 1792
        return {
            "x": _w((lambda *s: torch.randn(*s, dtype=torch.bfloat16) * 0.05)(B, S, D)),
            "w1": _w((lambda *s: torch.randn(*s, dtype=torch.bfloat16) * 0.05)(D, Dff)),
            "w2": _w((lambda *s: torch.randn(*s, dtype=torch.bfloat16) * 0.05)(Dff, D)),
        }
    _B_in = _B_setup()

    return {
        "A_u": _A_in["u"],
        "A_log_A_real": _A_in["log_A_real"],
        "A_A_imag": _A_in["A_imag"],
        "A_C_real": _A_in["C_real"],
        "A_C_imag": _A_in["C_imag"],
        "A_log_dt": _A_in["log_dt"],
        "A_D_skip": _A_in["D_skip"],
        "B_x": _B_in["x"],
        "B_w1": _B_in["w1"],
        "B_w2": _B_in["w2"],
    }

def reference(A_u, A_log_A_real, A_A_imag, A_C_real, A_C_imag, A_log_dt, A_D_skip, B_x, B_w1, B_w2):
    def _A_ref(u, log_A_real, A_imag, C_real, C_imag, log_dt, D_skip):
        L = u.shape[1]
        dt = torch.exp(log_dt)
        A = -torch.exp(log_A_real) + 1j * A_imag
        C = (C_real + 1j * C_imag) * dt[:, None]
        pos = (lambda x, dt: x.to(dt))(torch.arange(L), log_dt.dtype)
        P = torch.exp((A * dt[:, None])[:, :, None] * pos[None, None, :])
        K = 2.0 * torch.einsum("dn,dnl->dl", C, P).real
        L2 = 2 * L
        u_t = (lambda x, *d: x.permute(*d))(u, 0, 2, 1)
        Kf = (lambda x, *a, **k: torch.fft.rfft(x.float(), *a, **k))(K, L2)
        Uf = (lambda x, *a, **k: torch.fft.rfft(x.float(), *a, **k))(u_t, L2)
        y = (lambda x, *a, **k: torch.fft.irfft(x, *a, **k).to(torch.bfloat16))(Uf * Kf[None, :, :], L2)[:, :, :L]
        y = (lambda x, *d: x.permute(*d))(y, 0, 2, 1)
        return y + u * D_skip[None, None, :]

    def _B_ref(x, w1, w2):
        h = torch.einsum("bsd,df->bsf", x, w1)
        zero = torch.zeros_like(h)
        h = torch.maximum(h, zero)
        return torch.einsum("bsf,fd->bsd", h, w2)

    x = A_u
    xn = _layernorm(x, axis=-1)
    s = _A_ref(xn, A_log_A_real, A_A_imag, A_C_real, A_C_imag, A_log_dt, A_D_skip)
    g = _silu(_B_ref(xn, B_w1, B_w2))
    return x + s * g
```

```asm
; @launch kernel=ka_kernel grid=(312,1,1) block=(512,1,1) lds=69632
; @launch kernel=kb_kernel grid=(480,1,1) block=(256,1,1) lds=81920
.amdgcn_target "amdgcn-amd-amdhsa--gfx950"
.text
.globl ka_kernel
.p2align 8
.type ka_kernel,@function
ka_kernel:
    s_load_dwordx16 s[64:79], s[0:1], 0
    s_load_dwordx8 s[80:87], s[0:1], 64
    s_load_dwordx2 s[6:7], s[0:1], 96
    s_waitcnt lgkmcnt(0)
    s_mov_b32 s4, s64
    s_mov_b32 s5, s65
    s_cmp_ge_u32 s2, 256
    s_cbranch_scc1 ka_kernel_pf
    s_cmp_ge_u32 s2, 224
    s_cbranch_scc1 ka_kernel_ln
    s_mov_b32 s3, s2
    s_setprio 2
    s_mov_b32 s8, s66
    s_mov_b32 s9, s67
    s_mov_b32 s10, 229376
    s_mov_b32 s11, 0x00020000
    s_mov_b32 s12, s68
    s_mov_b32 s13, s69
    s_mov_b32 s14, 229376
    s_mov_b32 s15, 0x00020000
    s_mov_b32 s16, s70
    s_mov_b32 s17, s71
    s_mov_b32 s18, 229376
    s_mov_b32 s19, 0x00020000
    s_mov_b32 s20, s72
    s_mov_b32 s21, s73
    s_mov_b32 s22, 229376
    s_mov_b32 s23, 0x00020000
    s_mov_b32 s24, s74
    s_mov_b32 s25, s75
    s_mov_b32 s26, 896
    s_mov_b32 s27, 0x00020000
    s_add_u32 s44, s6, 4194304
    s_addc_u32 s45, s7, 0
    s_mov_b32 s46, 1892352
    s_mov_b32 s47, 0x00020000
    s_lshl_b32 s28, s3, 10
    v_lshlrev_b32 v1, 1, v0
    v_add_u32 v1, s28, v1
    v_lshrrev_b32 v3, 8, v0
    s_lshl_b32 s29, s3, 1
    v_add_u32 v2, s29, v3
    v_lshlrev_b32 v10, 1, v2
    buffer_load_ushort v4, v1, s[8:11], 0 offen
    buffer_load_ushort v5, v1, s[12:15], 0 offen
    buffer_load_ushort v6, v1, s[16:19], 0 offen
    buffer_load_ushort v7, v1, s[20:23], 0 offen
    buffer_load_ushort v8, v10, s[24:27], 0 offen

    v_and_b32 v1, 63, v0
    v_lshrrev_b32 v0, 6, v0
    v_mul_u32_u24 v14, 8448, v0
    v_lshrrev_b32 v10, 4, v1
    v_and_b32 v15, 15, v1
    v_mul_u32_u24 v15, 528, v15
    v_lshl_add_u32 v15, v10, 4, v15
    v_add_u32 v15, v15, v14
    v_lshl_add_u32 v14, v1, 2, v14
    s_waitcnt vmcnt(0)
    v_lshlrev_b32 v4, 16, v4
    v_lshlrev_b32 v5, 16, v5
    v_lshlrev_b32 v6, 16, v6
    v_lshlrev_b32 v7, 16, v7
    v_lshlrev_b32 v8, 16, v8

    s_mov_b32 s30, 0x3fb8aa3b
    s_mov_b32 s31, 0x32a57060
    v_mul_f32 v10, s30, v8
    v_fma_f32 v11, v8, s30, -v10
    v_fma_f32 v11, v8, s31, v11
    v_exp_f32 v9, v10
    v_mul_f32 v11, 0x3f317218, v11
    v_fma_f32 v9, v9, v11, v9
    v_cvt_pk_bf16_f32 v9, v9, v9
    v_lshlrev_b32 v9, 16, v9
    s_mov_b32 s30, 0x3fb8aa3b
    s_mov_b32 s31, 0x32a57060
    v_mul_f32 v10, s30, v4
    v_fma_f32 v11, v4, s30, -v10
    v_fma_f32 v11, v4, s31, v11
    v_exp_f32 v12, v10
    v_mul_f32 v11, 0x3f317218, v11
    v_fma_f32 v12, v12, v11, v12
    v_cvt_pk_bf16_f32 v12, v12, v12
    v_lshlrev_b32 v12, 16, v12
    v_mul_f32 v12, v12, v9
    v_mul_f32 v13, v5, v9
    v_mul_f32 v6, v6, v9
    v_mul_f32 v7, v7, v9
    v_add_f32 v6, v6, v6
    v_add_f32 v7, v7, v7
    v_mul_f32 v12, 0xbfb8aa3b, v12
    v_mul_f32 v13, 0x3e22f983, v13
    v_mul_f32 v16, 0x41000000, v12
    v_mul_f32 v17, 0x41000000, v13
    v_exp_f32 v16, v16
    v_fract_f32 v17, v17
    v_cos_f32 v20, v17
    v_sin_f32 v21, v17
    s_nop 0
    v_mul_f32 v20, v20, v16
    v_mul_f32 v21, v21, v16
    v_pk_mul_f32 v[16:17], v[20:21], v[20:21] op_sel:[1,1] op_sel_hi:[1,0]
    v_pk_fma_f32 v[22:23], v[20:21], v[20:21], v[16:17] op_sel:[0,0,0] op_sel_hi:[0,1,1] neg_lo:[0,0,1] neg_hi:[0,0,0]
    v_pk_mul_f32 v[16:17], v[22:23], v[22:23] op_sel:[1,1] op_sel_hi:[1,0]
    v_pk_fma_f32 v[24:25], v[22:23], v[22:23], v[16:17] op_sel:[0,0,0] op_sel_hi:[0,1,1] neg_lo:[0,0,1] neg_hi:[0,0,0]
    v_pk_mul_f32 v[16:17], v[24:25], v[24:25] op_sel:[1,1] op_sel_hi:[1,0]
    v_pk_fma_f32 v[26:27], v[24:25], v[24:25], v[16:17] op_sel:[0,0,0] op_sel_hi:[0,1,1] neg_lo:[0,0,1] neg_hi:[0,0,0]
    v_pk_mul_f32 v[16:17], v[20:21], v[22:23] op_sel:[1,1] op_sel_hi:[1,0]
    v_pk_fma_f32 v[28:29], v[20:21], v[22:23], v[16:17] op_sel:[0,0,0] op_sel_hi:[0,1,1] neg_lo:[0,0,1] neg_hi:[0,0,0]
    v_pk_mul_f32 v[16:17], v[24:25], v[20:21] op_sel:[1,1] op_sel_hi:[1,0]
    v_pk_fma_f32 v[30:31], v[24:25], v[20:21], v[16:17] op_sel:[0,0,0] op_sel_hi:[0,1,1] neg_lo:[0,0,1] neg_hi:[0,0,0]
    v_pk_mul_f32 v[16:17], v[24:25], v[22:23] op_sel:[1,1] op_sel_hi:[1,0]
    v_pk_fma_f32 v[32:33], v[24:25], v[22:23], v[16:17] op_sel:[0,0,0] op_sel_hi:[0,1,1] neg_lo:[0,0,1] neg_hi:[0,0,0]
    v_pk_mul_f32 v[16:17], v[24:25], v[28:29] op_sel:[1,1] op_sel_hi:[1,0]
    v_pk_fma_f32 v[34:35], v[24:25], v[28:29], v[16:17] op_sel:[0,0,0] op_sel_hi:[0,1,1] neg_lo:[0,0,1] neg_hi:[0,0,0]
    v_mov_b32 v36, 0x3f80
    v_mov_b32 v37, 0
    ds_write_b32 v14, v36
    ds_write_b32 v14, v37 offset:256
    v_cvt_pk_bf16_f32 v4, v20, v21
    v_lshlrev_b32 v8, 16, v4
    v_and_b32 v9, 0xffff0000, v4
    v_pk_add_f32 v[8:9], v[20:21], v[8:9] neg_lo:[0,1] neg_hi:[0,1]
    v_cvt_pk_bf16_f32 v5, v8, v9
    ds_write_b32 v14, v4 offset:528
    ds_write_b32 v14, v5 offset:784
    v_cvt_pk_bf16_f32 v4, v22, v23
    v_lshlrev_b32 v8, 16, v4
    v_and_b32 v9, 0xffff0000, v4
    v_pk_add_f32 v[8:9], v[22:23], v[8:9] neg_lo:[0,1] neg_hi:[0,1]
    v_cvt_pk_bf16_f32 v5, v8, v9
    ds_write_b32 v14, v4 offset:1056
    ds_write_b32 v14, v5 offset:1312
    v_cvt_pk_bf16_f32 v4, v28, v29
    v_lshlrev_b32 v8, 16, v4
    v_and_b32 v9, 0xffff0000, v4
    v_pk_add_f32 v[8:9], v[28:29], v[8:9] neg_lo:[0,1] neg_hi:[0,1]
    v_cvt_pk_bf16_f32 v5, v8, v9
    ds_write_b32 v14, v4 offset:1584
    ds_write_b32 v14, v5 offset:1840
    v_cvt_pk_bf16_f32 v4, v24, v25
    v_lshlrev_b32 v8, 16, v4
    v_and_b32 v9, 0xffff0000, v4
    v_pk_add_f32 v[8:9], v[24:25], v[8:9] neg_lo:[0,1] neg_hi:[0,1]
    v_cvt_pk_bf16_f32 v5, v8, v9
    ds_write_b32 v14, v4 offset:2112
    ds_write_b32 v14, v5 offset:2368
    v_cvt_pk_bf16_f32 v4, v30, v31
    v_lshlrev_b32 v8, 16, v4
    v_and_b32 v9, 0xffff0000, v4
    v_pk_add_f32 v[8:9], v[30:31], v[8:9] neg_lo:[0,1] neg_hi:[0,1]
    v_cvt_pk_bf16_f32 v5, v8, v9
    ds_write_b32 v14, v4 offset:2640
    ds_write_b32 v14, v5 offset:2896
    v_cvt_pk_bf16_f32 v4, v32, v33
    v_lshlrev_b32 v8, 16, v4
    v_and_b32 v9, 0xffff0000, v4
    v_pk_add_f32 v[8:9], v[32:33], v[8:9] neg_lo:[0,1] neg_hi:[0,1]
    v_cvt_pk_bf16_f32 v5, v8, v9
    ds_write_b32 v14, v4 offset:3168
    ds_write_b32 v14, v5 offset:3424
    v_cvt_pk_bf16_f32 v4, v34, v35
    v_lshlrev_b32 v8, 16, v4
    v_and_b32 v9, 0xffff0000, v4
    v_pk_add_f32 v[8:9], v[34:35], v[8:9] neg_lo:[0,1] neg_hi:[0,1]
    v_cvt_pk_bf16_f32 v5, v8, v9
    ds_write_b32 v14, v4 offset:3696
    ds_write_b32 v14, v5 offset:3952
    v_cvt_pk_bf16_f32 v4, v26, v27
    v_lshlrev_b32 v8, 16, v4
    v_and_b32 v9, 0xffff0000, v4
    v_pk_add_f32 v[8:9], v[26:27], v[8:9] neg_lo:[0,1] neg_hi:[0,1]
    v_cvt_pk_bf16_f32 v5, v8, v9
    ds_write_b32 v14, v4 offset:4224
    ds_write_b32 v14, v5 offset:4480
    v_pk_mul_f32 v[16:17], v[26:27], v[20:21] op_sel:[1,1] op_sel_hi:[1,0]
    v_pk_fma_f32 v[36:37], v[26:27], v[20:21], v[16:17] op_sel:[0,0,0] op_sel_hi:[0,1,1] neg_lo:[0,0,1] neg_hi:[0,0,0]
    v_cvt_pk_bf16_f32 v4, v36, v37
    v_lshlrev_b32 v8, 16, v4
    v_and_b32 v9, 0xffff0000, v4
    v_pk_add_f32 v[8:9], v[36:37], v[8:9] neg_lo:[0,1] neg_hi:[0,1]
    v_cvt_pk_bf16_f32 v5, v8, v9
    ds_write_b32 v14, v4 offset:4752
    ds_write_b32 v14, v5 offset:5008
    v_pk_mul_f32 v[16:17], v[26:27], v[22:23] op_sel:[1,1] op_sel_hi:[1,0]
    v_pk_fma_f32 v[36:37], v[26:27], v[22:23], v[16:17] op_sel:[0,0,0] op_sel_hi:[0,1,1] neg_lo:[0,0,1] neg_hi:[0,0,0]
    v_cvt_pk_bf16_f32 v4, v36, v37
    v_lshlrev_b32 v8, 16, v4
    v_and_b32 v9, 0xffff0000, v4
    v_pk_add_f32 v[8:9], v[36:37], v[8:9] neg_lo:[0,1] neg_hi:[0,1]
    v_cvt_pk_bf16_f32 v5, v8, v9
    ds_write_b32 v14, v4 offset:5280
    ds_write_b32 v14, v5 offset:5536
    v_pk_mul_f32 v[16:17], v[26:27], v[28:29] op_sel:[1,1] op_sel_hi:[1,0]
    v_pk_fma_f32 v[36:37], v[26:27], v[28:29], v[16:17] op_sel:[0,0,0] op_sel_hi:[0,1,1] neg_lo:[0,0,1] neg_hi:[0,0,0]
    v_cvt_pk_bf16_f32 v4, v36, v37
    v_lshlrev_b32 v8, 16, v4
    v_and_b32 v9, 0xffff0000, v4
    v_pk_add_f32 v[8:9], v[36:37], v[8:9] neg_lo:[0,1] neg_hi:[0,1]
    v_cvt_pk_bf16_f32 v5, v8, v9
    ds_write_b32 v14, v4 offset:5808
    ds_write_b32 v14, v5 offset:6064
    v_pk_mul_f32 v[16:17], v[26:27], v[24:25] op_sel:[1,1] op_sel_hi:[1,0]
    v_pk_fma_f32 v[36:37], v[26:27], v[24:25], v[16:17] op_sel:[0,0,0] op_sel_hi:[0,1,1] neg_lo:[0,0,1] neg_hi:[0,0,0]
    v_cvt_pk_bf16_f32 v4, v36, v37
    v_lshlrev_b32 v8, 16, v4
    v_and_b32 v9, 0xffff0000, v4
    v_pk_add_f32 v[8:9], v[36:37], v[8:9] neg_lo:[0,1] neg_hi:[0,1]
    v_cvt_pk_bf16_f32 v5, v8, v9
    ds_write_b32 v14, v4 offset:6336
    ds_write_b32 v14, v5 offset:6592
    v_pk_mul_f32 v[16:17], v[26:27], v[30:31] op_sel:[1,1] op_sel_hi:[1,0]
    v_pk_fma_f32 v[36:37], v[26:27], v[30:31], v[16:17] op_sel:[0,0,0] op_sel_hi:[0,1,1] neg_lo:[0,0,1] neg_hi:[0,0,0]
    v_cvt_pk_bf16_f32 v4, v36, v37
    v_lshlrev_b32 v8, 16, v4
    v_and_b32 v9, 0xffff0000, v4
    v_pk_add_f32 v[8:9], v[36:37], v[8:9] neg_lo:[0,1] neg_hi:[0,1]
    v_cvt_pk_bf16_f32 v5, v8, v9
    ds_write_b32 v14, v4 offset:6864
    ds_write_b32 v14, v5 offset:7120
    v_pk_mul_f32 v[16:17], v[26:27], v[32:33] op_sel:[1,1] op_sel_hi:[1,0]
    v_pk_fma_f32 v[36:37], v[26:27], v[32:33], v[16:17] op_sel:[0,0,0] op_sel_hi:[0,1,1] neg_lo:[0,0,1] neg_hi:[0,0,0]
    v_cvt_pk_bf16_f32 v4, v36, v37
    v_lshlrev_b32 v8, 16, v4
    v_and_b32 v9, 0xffff0000, v4
    v_pk_add_f32 v[8:9], v[36:37], v[8:9] neg_lo:[0,1] neg_hi:[0,1]
    v_cvt_pk_bf16_f32 v5, v8, v9
    ds_write_b32 v14, v4 offset:7392
    ds_write_b32 v14, v5 offset:7648
    v_pk_mul_f32 v[16:17], v[26:27], v[34:35] op_sel:[1,1] op_sel_hi:[1,0]
    v_pk_fma_f32 v[36:37], v[26:27], v[34:35], v[16:17] op_sel:[0,0,0] op_sel_hi:[0,1,1] neg_lo:[0,0,1] neg_hi:[0,0,0]
    v_cvt_pk_bf16_f32 v4, v36, v37
    v_lshlrev_b32 v8, 16, v4
    v_and_b32 v9, 0xffff0000, v4
    v_pk_add_f32 v[8:9], v[36:37], v[8:9] neg_lo:[0,1] neg_hi:[0,1]
    v_cvt_pk_bf16_f32 v5, v8, v9
    ds_write_b32 v14, v4 offset:7920
    ds_write_b32 v14, v5 offset:8176
    s_waitcnt lgkmcnt(0)
    ds_read_b128 v[64:67], v15 offset:0
    ds_read_b128 v[80:83], v15 offset:256
    ds_read_b128 v[68:71], v15 offset:64
    ds_read_b128 v[84:87], v15 offset:320
    ds_read_b128 v[72:75], v15 offset:128
    ds_read_b128 v[88:91], v15 offset:384
    ds_read_b128 v[76:79], v15 offset:192
    ds_read_b128 v[92:95], v15 offset:448
    v_mul_f32 v16, 0x3f800000, v12
    v_mul_f32 v17, 0x3f800000, v13
    v_exp_f32 v16, v16
    v_fract_f32 v17, v17
    v_cos_f32 v20, v17
    v_sin_f32 v21, v17
    s_nop 0
    v_mul_f32 v20, v20, v16
    v_mul_f32 v21, v21, v16
    v_pk_mul_f32 v[16:17], v[20:21], v[20:21] op_sel:[1,1] op_sel_hi:[1,0]
    v_pk_fma_f32 v[22:23], v[20:21], v[20:21], v[16:17] op_sel:[0,0,0] op_sel_hi:[0,1,1] neg_lo:[0,0,1] neg_hi:[0,0,0]
    v_pk_mul_f32 v[16:17], v[22:23], v[22:23] op_sel:[1,1] op_sel_hi:[1,0]
    v_pk_fma_f32 v[26:27], v[22:23], v[22:23], v[16:17] op_sel:[0,0,0] op_sel_hi:[0,1,1] neg_lo:[0,0,1] neg_hi:[0,0,0]
    v_pk_mul_f32 v[16:17], v[20:21], v[22:23] op_sel:[1,1] op_sel_hi:[1,0]
    v_pk_fma_f32 v[24:25], v[20:21], v[22:23], v[16:17] op_sel:[0,0,0] op_sel_hi:[0,1,1] neg_lo:[0,0,1] neg_hi:[0,0,0]
    v_pk_mul_f32 v[16:17], v[20:21], v[26:27] op_sel:[1,1] op_sel_hi:[1,0]
    v_pk_fma_f32 v[28:29], v[20:21], v[26:27], v[16:17] op_sel:[0,0,0] op_sel_hi:[0,1,1] neg_lo:[0,0,1] neg_hi:[0,0,0]
    v_pk_mul_f32 v[16:17], v[22:23], v[26:27] op_sel:[1,1] op_sel_hi:[1,0]
    v_pk_fma_f32 v[30:31], v[22:23], v[26:27], v[16:17] op_sel:[0,0,0] op_sel_hi:[0,1,1] neg_lo:[0,0,1] neg_hi:[0,0,0]
    v_pk_mul_f32 v[16:17], v[24:25], v[26:27] op_sel:[1,1] op_sel_hi:[1,0]
    v_pk_fma_f32 v[32:33], v[24:25], v[26:27], v[16:17] op_sel:[0,0,0] op_sel_hi:[0,1,1] neg_lo:[0,0,1] neg_hi:[0,0,0]
    v_mul_f32 v16, 0x43000000, v12
    v_mul_f32 v17, 0x43000000, v13
    v_exp_f32 v16, v16
    v_fract_f32 v17, v17
    v_cos_f32 v48, v17
    v_sin_f32 v49, v17
    s_nop 0
    v_mul_f32 v48, v48, v16
    v_mul_f32 v49, v49, v16
    v_pk_mul_f32 v[16:17], v[48:49], v[48:49] op_sel:[1,1] op_sel_hi:[1,0]
    v_pk_fma_f32 v[50:51], v[48:49], v[48:49], v[16:17] op_sel:[0,0,0] op_sel_hi:[0,1,1] neg_lo:[0,0,1] neg_hi:[0,0,0]
    v_pk_mul_f32 v[16:17], v[50:51], v[50:51] op_sel:[1,1] op_sel_hi:[1,0]
    v_pk_fma_f32 v[52:53], v[50:51], v[50:51], v[16:17] op_sel:[0,0,0] op_sel_hi:[0,1,1] neg_lo:[0,0,1] neg_hi:[0,0,0]
    v_pk_mul_f32 v[16:17], v[52:53], v[52:53] op_sel:[1,1] op_sel_hi:[1,0]
    v_pk_fma_f32 v[54:55], v[52:53], v[52:53], v[16:17] op_sel:[0,0,0] op_sel_hi:[0,1,1] neg_lo:[0,0,1] neg_hi:[0,0,0]
    v_pk_mul_f32 v[16:17], v[54:55], v[54:55] op_sel:[1,1] op_sel_hi:[1,0]
    v_pk_fma_f32 v[56:57], v[54:55], v[54:55], v[16:17] op_sel:[0,0,0] op_sel_hi:[0,1,1] neg_lo:[0,0,1] neg_hi:[0,0,0]
    v_pk_mul_f32 v[16:17], v[6:7], v[48:49] op_sel:[1,1] op_sel_hi:[1,0]
    v_pk_fma_f32 v[34:35], v[6:7], v[48:49], v[16:17] op_sel:[0,0,0] op_sel_hi:[0,1,1] neg_lo:[0,0,1] neg_hi:[0,0,0]
    v_pk_mul_f32 v[16:17], v[6:7], v[50:51] op_sel:[1,1] op_sel_hi:[1,0]
    v_pk_fma_f32 v[36:37], v[6:7], v[50:51], v[16:17] op_sel:[0,0,0] op_sel_hi:[0,1,1] neg_lo:[0,0,1] neg_hi:[0,0,0]
    v_pk_mul_f32 v[16:17], v[34:35], v[50:51] op_sel:[1,1] op_sel_hi:[1,0]
    v_pk_fma_f32 v[38:39], v[34:35], v[50:51], v[16:17] op_sel:[0,0,0] op_sel_hi:[0,1,1] neg_lo:[0,0,1] neg_hi:[0,0,0]
    v_pk_mul_f32 v[16:17], v[6:7], v[52:53] op_sel:[1,1] op_sel_hi:[1,0]
    v_pk_fma_f32 v[40:41], v[6:7], v[52:53], v[16:17] op_sel:[0,0,0] op_sel_hi:[0,1,1] neg_lo:[0,0,1] neg_hi:[0,0,0]
    v_pk_mul_f32 v[16:17], v[34:35], v[52:53] op_sel:[1,1] op_sel_hi:[1,0]
    v_pk_fma_f32 v[42:43], v[34:35], v[52:53], v[16:17] op_sel:[0,0,0] op_sel_hi:[0,1,1] neg_lo:[0,0,1] neg_hi:[0,0,0]
    v_pk_mul_f32 v[16:17], v[36:37], v[52:53] op_sel:[1,1] op_sel_hi:[1,0]
    v_pk_fma_f32 v[44:45], v[36:37], v[52:53], v[16:17] op_sel:[0,0,0] op_sel_hi:[0,1,1] neg_lo:[0,0,1] neg_hi:[0,0,0]
    v_pk_mul_f32 v[16:17], v[38:39], v[52:53] op_sel:[1,1] op_sel_hi:[1,0]
    v_pk_fma_f32 v[46:47], v[38:39], v[52:53], v[16:17] op_sel:[0,0,0] op_sel_hi:[0,1,1] neg_lo:[0,0,1] neg_hi:[0,0,0]
    v_mov_b32 v112, 0
    v_mov_b32 v113, 0
    v_mov_b32 v114, 0
    v_mov_b32 v115, 0
    v_mov_b32 v116, 0
    v_mov_b32 v117, 0
    v_mov_b32 v118, 0
    v_mov_b32 v119, 0
    v_mov_b32 v120, 0
    v_mov_b32 v121, 0
    v_mov_b32 v122, 0
    v_mov_b32 v123, 0
    s_waitcnt lgkmcnt(0)
    v_pk_mul_f32 v[16:17], v[6:7], v[54:55] op_sel:[1,1] op_sel_hi:[1,0]
    v_pk_fma_f32 v[58:59], v[6:7], v[54:55], v[16:17] op_sel:[0,0,0] op_sel_hi:[0,1,1] neg_lo:[0,0,1] neg_hi:[1,0,1]
    v_cvt_pk_bf16_f32 v4, v58, v59
    v_lshlrev_b32 v8, 16, v4
    v_and_b32 v9, 0xffff0000, v4
    v_pk_add_f32 v[8:9], v[58:59], v[8:9] neg_lo:[0,1] neg_hi:[0,1]
    v_cvt_pk_bf16_f32 v5, v8, v9
    ds_write_b32 v14, v4 offset:0
    ds_write_b32 v14, v5 offset:256
    v_pk_mul_f32 v[16:17], v[34:35], v[54:55] op_sel:[1,1] op_sel_hi:[1,0]
    v_pk_fma_f32 v[58:59], v[34:35], v[54:55], v[16:17] op_sel:[0,0,0] op_sel_hi:[0,1,1] neg_lo:[0,0,1] neg_hi:[1,0,1]
    v_cvt_pk_bf16_f32 v4, v58, v59
    v_lshlrev_b32 v8, 16, v4
    v_and_b32 v9, 0xffff0000, v4
    v_pk_add_f32 v[8:9], v[58:59], v[8:9] neg_lo:[0,1] neg_hi:[0,1]
    v_cvt_pk_bf16_f32 v5, v8, v9
    ds_write_b32 v14, v4 offset:528
    ds_write_b32 v14, v5 offset:784
    v_pk_mul_f32 v[16:17], v[36:37], v[54:55] op_sel:[1,1] op_sel_hi:[1,0]
    v_pk_fma_f32 v[58:59], v[36:37], v[54:55], v[16:17] op_sel:[0,0,0] op_sel_hi:[0,1,1] neg_lo:[0,0,1] neg_hi:[1,0,1]
    v_cvt_pk_bf16_f32 v4, v58, v59
    v_lshlrev_b32 v8, 16, v4
    v_and_b32 v9, 0xffff0000, v4
    v_pk_add_f32 v[8:9], v[58:59], v[8:9] neg_lo:[0,1] neg_hi:[0,1]
    v_cvt_pk_bf16_f32 v5, v8, v9
    ds_write_b32 v14, v4 offset:1056
    ds_write_b32 v14, v5 offset:1312
    v_pk_mul_f32 v[16:17], v[38:39], v[54:55] op_sel:[1,1] op_sel_hi:[1,0]
    v_pk_fma_f32 v[58:59], v[38:39], v[54:55], v[16:17] op_sel:[0,0,0] op_sel_hi:[0,1,1] neg_lo:[0,0,1] neg_hi:[1,0,1]
    v_cvt_pk_bf16_f32 v4, v58, v59
    v_lshlrev_b32 v8, 16, v4
    v_and_b32 v9, 0xffff0000, v4
    v_pk_add_f32 v[8:9], v[58:59], v[8:9] neg_lo:[0,1] neg_hi:[0,1]
    v_cvt_pk_bf16_f32 v5, v8, v9
    ds_write_b32 v14, v4 offset:1584
    ds_write_b32 v14, v5 offset:1840
    v_pk_mul_f32 v[16:17], v[40:41], v[54:55] op_sel:[1,1] op_sel_hi:[1,0]
    v_pk_fma_f32 v[58:59], v[40:41], v[54:55], v[16:17] op_sel:[0,0,0] op_sel_hi:[0,1,1] neg_lo:[0,0,1] neg_hi:[1,0,1]
    v_cvt_pk_bf16_f32 v4, v58, v59
    v_lshlrev_b32 v8, 16, v4
    v_and_b32 v9, 0xffff0000, v4
    v_pk_add_f32 v[8:9], v[58:59], v[8:9] neg_lo:[0,1] neg_hi:[0,1]
    v_cvt_pk_bf16_f32 v5, v8, v9
    ds_write_b32 v14, v4 offset:2112
    ds_write_b32 v14, v5 offset:2368
    v_pk_mul_f32 v[16:17], v[42:43], v[54:55] op_sel:[1,1] op_sel_hi:[1,0]
    v_pk_fma_f32 v[58:59], v[42:43], v[54:55], v[16:17] op_sel:[0,0,0] op_sel_hi:[0,1,1] neg_lo:[0,0,1] neg_hi:[1,0,1]
    v_cvt_pk_bf16_f32 v4, v58, v59
    v_lshlrev_b32 v8, 16, v4
    v_and_b32 v9, 0xffff0000, v4
    v_pk_add_f32 v[8:9], v[58:59], v[8:9] neg_lo:[0,1] neg_hi:[0,1]
    v_cvt_pk_bf16_f32 v5, v8, v9
    ds_write_b32 v14, v4 offset:2640
    ds_write_b32 v14, v5 offset:2896
    v_pk_mul_f32 v[16:17], v[44:45], v[54:55] op_sel:[1,1] op_sel_hi:[1,0]
    v_pk_fma_f32 v[58:59], v[44:45], v[54:55], v[16:17] op_sel:[0,0,0] op_sel_hi:[0,1,1] neg_lo:[0,0,1] neg_hi:[1,0,1]
    v_cvt_pk_bf16_f32 v4, v58, v59
    v_lshlrev_b32 v8, 16, v4
    v_and_b32 v9, 0xffff0000, v4
    v_pk_add_f32 v[8:9], v[58:59], v[8:9] neg_lo:[0,1] neg_hi:[0,1]
    v_cvt_pk_bf16_f32 v5, v8, v9
    ds_write_b32 v14, v4 offset:3168
    ds_write_b32 v14, v5 offset:3424
    v_pk_mul_f32 v[16:17], v[46:47], v[54:55] op_sel:[1,1] op_sel_hi:[1,0]
    v_pk_fma_f32 v[58:59], v[46:47], v[54:55], v[16:17] op_sel:[0,0,0] op_sel_hi:[0,1,1] neg_lo:[0,0,1] neg_hi:[1,0,1]
    v_cvt_pk_bf16_f32 v4, v58, v59
    v_lshlrev_b32 v8, 16, v4
    v_and_b32 v9, 0xffff0000, v4
    v_pk_add_f32 v[8:9], v[58:59], v[8:9] neg_lo:[0,1] neg_hi:[0,1]
    v_cvt_pk_bf16_f32 v5, v8, v9
    ds_write_b32 v14, v4 offset:3696
    ds_write_b32 v14, v5 offset:3952
    v_pk_mul_f32 v[16:17], v[6:7], v[56:57] op_sel:[1,1] op_sel_hi:[1,0]
    v_pk_fma_f32 v[58:59], v[6:7], v[56:57], v[16:17] op_sel:[0,0,0] op_sel_hi:[0,1,1] neg_lo:[0,0,1] neg_hi:[1,0,1]
    v_cvt_pk_bf16_f32 v4, v58, v59
    v_lshlrev_b32 v8, 16, v4
    v_and_b32 v9, 0xffff0000, v4
    v_pk_add_f32 v[8:9], v[58:59], v[8:9] neg_lo:[0,1] neg_hi:[0,1]
    v_cvt_pk_bf16_f32 v5, v8, v9
    ds_write_b32 v14, v4 offset:4224
    ds_write_b32 v14, v5 offset:4480
    v_mov_b32 v58, 0
    ds_write_b32 v14, v58 offset:4752
    ds_write_b32 v14, v58 offset:5008
    v_mov_b32 v58, 0
    ds_write_b32 v14, v58 offset:5280
    ds_write_b32 v14, v58 offset:5536
    v_mov_b32 v58, 0
    ds_write_b32 v14, v58 offset:5808
    ds_write_b32 v14, v58 offset:6064
    v_mov_b32 v58, 0
    ds_write_b32 v14, v58 offset:6336
    ds_write_b32 v14, v58 offset:6592
    v_mov_b32 v58, 0
    ds_write_b32 v14, v58 offset:6864
    ds_write_b32 v14, v58 offset:7120
    v_mov_b32 v58, 0
    ds_write_b32 v14, v58 offset:7392
    ds_write_b32 v14, v58 offset:7648
    v_mov_b32 v58, 0
    ds_write_b32 v14, v58 offset:7920
    ds_write_b32 v14, v58 offset:8176
    s_waitcnt lgkmcnt(0)
    ds_read_b128 v[96:99], v15 offset:0
    ds_read_b128 v[100:103], v15 offset:64
    ds_read_b128 v[104:107], v15 offset:128
    ds_read_b128 v[108:111], v15 offset:192
    s_waitcnt lgkmcnt(3)
    v_mfma_f32_16x16x32_bf16 v[120:123], v[96:99], v[64:67], v[120:123]
    v_mfma_f32_16x16x32_bf16 v[120:123], v[96:99], v[80:83], v[120:123]
    s_waitcnt lgkmcnt(2)
    v_mfma_f32_16x16x32_bf16 v[120:123], v[100:103], v[68:71], v[120:123]
    v_mfma_f32_16x16x32_bf16 v[120:123], v[100:103], v[84:87], v[120:123]
    s_waitcnt lgkmcnt(1)
    v_mfma_f32_16x16x32_bf16 v[120:123], v[104:107], v[72:75], v[120:123]
    v_mfma_f32_16x16x32_bf16 v[120:123], v[104:107], v[88:91], v[120:123]
    s_waitcnt lgkmcnt(0)
    v_mfma_f32_16x16x32_bf16 v[120:123], v[108:111], v[76:79], v[120:123]
    v_mfma_f32_16x16x32_bf16 v[120:123], v[108:111], v[92:95], v[120:123]
    ds_read_b128 v[96:99], v15 offset:256
    ds_read_b128 v[100:103], v15 offset:320
    ds_read_b128 v[104:107], v15 offset:384
    ds_read_b128 v[108:111], v15 offset:448
    s_waitcnt lgkmcnt(3)
    v_mfma_f32_16x16x32_bf16 v[120:123], v[96:99], v[64:67], v[120:123]
    s_waitcnt lgkmcnt(2)
    v_mfma_f32_16x16x32_bf16 v[120:123], v[100:103], v[68:71], v[120:123]
    s_waitcnt lgkmcnt(1)
    v_mfma_f32_16x16x32_bf16 v[120:123], v[104:107], v[72:75], v[120:123]
    s_waitcnt lgkmcnt(0)
    v_mfma_f32_16x16x32_bf16 v[120:123], v[108:111], v[76:79], v[120:123]
    s_waitcnt lgkmcnt(0)
    v_mov_b32 v58, v36
    v_sub_f32 v59, 0, v37
    v_cvt_pk_bf16_f32 v4, v58, v59
    v_lshlrev_b32 v8, 16, v4
    v_and_b32 v9, 0xffff0000, v4
    v_pk_add_f32 v[8:9], v[58:59], v[8:9] neg_lo:[0,1] neg_hi:[0,1]
    v_cvt_pk_bf16_f32 v5, v8, v9
    ds_write_b32 v14, v4 offset:0
    ds_write_b32 v14, v5 offset:256
    v_pk_mul_f32 v[16:17], v[36:37], v[22:23] op_sel:[1,1] op_sel_hi:[1,0]
    v_pk_fma_f32 v[58:59], v[36:37], v[22:23], v[16:17] op_sel:[0,0,0] op_sel_hi:[0,1,1] neg_lo:[0,0,1] neg_hi:[1,0,1]
    v_cvt_pk_bf16_f32 v4, v58, v59
    v_lshlrev_b32 v8, 16, v4
    v_and_b32 v9, 0xffff0000, v4
    v_pk_add_f32 v[8:9], v[58:59], v[8:9] neg_lo:[0,1] neg_hi:[0,1]
    v_cvt_pk_bf16_f32 v5, v8, v9
    ds_write_b32 v14, v4 offset:528
    ds_write_b32 v14, v5 offset:784
    v_pk_mul_f32 v[16:17], v[36:37], v[26:27] op_sel:[1,1] op_sel_hi:[1,0]
    v_pk_fma_f32 v[58:59], v[36:37], v[26:27], v[16:17] op_sel:[0,0,0] op_sel_hi:[0,1,1] neg_lo:[0,0,1] neg_hi:[1,0,1]
    v_cvt_pk_bf16_f32 v4, v58, v59
    v_lshlrev_b32 v8, 16, v4
    v_and_b32 v9, 0xffff0000, v4
    v_pk_add_f32 v[8:9], v[58:59], v[8:9] neg_lo:[0,1] neg_hi:[0,1]
    v_cvt_pk_bf16_f32 v5, v8, v9
    ds_write_b32 v14, v4 offset:1056
    ds_write_b32 v14, v5 offset:1312
    v_pk_mul_f32 v[16:17], v[36:37], v[30:31] op_sel:[1,1] op_sel_hi:[1,0]
    v_pk_fma_f32 v[58:59], v[36:37], v[30:31], v[16:17] op_sel:[0,0,0] op_sel_hi:[0,1,1] neg_lo:[0,0,1] neg_hi:[1,0,1]
    v_cvt_pk_bf16_f32 v4, v58, v59
    v_lshlrev_b32 v8, 16, v4
    v_and_b32 v9, 0xffff0000, v4
    v_pk_add_f32 v[8:9], v[58:59], v[8:9] neg_lo:[0,1] neg_hi:[0,1]
    v_cvt_pk_bf16_f32 v5, v8, v9
    ds_write_b32 v14, v4 offset:1584
    ds_write_b32 v14, v5 offset:1840
    v_mov_b32 v58, v38
    v_sub_f32 v59, 0, v39
    v_cvt_pk_bf16_f32 v4, v58, v59
    v_lshlrev_b32 v8, 16, v4
    v_and_b32 v9, 0xffff0000, v4
    v_pk_add_f32 v[8:9], v[58:59], v[8:9] neg_lo:[0,1] neg_hi:[0,1]
    v_cvt_pk_bf16_f32 v5, v8, v9
    ds_write_b32 v14, v4 offset:2112
    ds_write_b32 v14, v5 offset:2368
    v_pk_mul_f32 v[16:17], v[38:39], v[22:23] op_sel:[1,1] op_sel_hi:[1,0]
    v_pk_fma_f32 v[58:59], v[38:39], v[22:23], v[16:17] op_sel:[0,0,0] op_sel_hi:[0,1,1] neg_lo:[0,0,1] neg_hi:[1,0,1]
    v_cvt_pk_bf16_f32 v4, v58, v59
    v_lshlrev_b32 v8, 16, v4
    v_and_b32 v9, 0xffff0000, v4
    v_pk_add_f32 v[8:9], v[58:59], v[8:9] neg_lo:[0,1] neg_hi:[0,1]
    v_cvt_pk_bf16_f32 v5, v8, v9
    ds_write_b32 v14, v4 offset:2640
    ds_write_b32 v14, v5 offset:2896
    v_pk_mul_f32 v[16:17], v[38:39], v[26:27] op_sel:[1,1] op_sel_hi:[1,0]
    v_pk_fma_f32 v[58:59], v[38:39], v[26:27], v[16:17] op_sel:[0,0,0] op_sel_hi:[0,1,1] neg_lo:[0,0,1] neg_hi:[1,0,1]
    v_cvt_pk_bf16_f32 v4, v58, v59
    v_lshlrev_b32 v8, 16, v4
    v_and_b32 v9, 0xffff0000, v4
    v_pk_add_f32 v[8:9], v[58:59], v[8:9] neg_lo:[0,1] neg_hi:[0,1]
    v_cvt_pk_bf16_f32 v5, v8, v9
    ds_write_b32 v14, v4 offset:3168
    ds_write_b32 v14, v5 offset:3424
    v_pk_mul_f32 v[16:17], v[38:39], v[30:31] op_sel:[1,1] op_sel_hi:[1,0]
    v_pk_fma_f32 v[58:59], v[38:39], v[30:31], v[16:17] op_sel:[0,0,0] op_sel_hi:[0,1,1] neg_lo:[0,0,1] neg_hi:[1,0,1]
    v_cvt_pk_bf16_f32 v4, v58, v59
    v_lshlrev_b32 v8, 16, v4
    v_and_b32 v9, 0xffff0000, v4
    v_pk_add_f32 v[8:9], v[58:59], v[8:9] neg_lo:[0,1] neg_hi:[0,1]
    v_cvt_pk_bf16_f32 v5, v8, v9
    ds_write_b32 v14, v4 offset:3696
    ds_write_b32 v14, v5 offset:3952
    v_mov_b32 v58, v40
    v_sub_f32 v59, 0, v41
    v_cvt_pk_bf16_f32 v4, v58, v59
    v_lshlrev_b32 v8, 16, v4
    v_and_b32 v9, 0xffff0000, v4
    v_pk_add_f32 v[8:9], v[58:59], v[8:9] neg_lo:[0,1] neg_hi:[0,1]
    v_cvt_pk_bf16_f32 v5, v8, v9
    ds_write_b32 v14, v4 offset:4224
    ds_write_b32 v14, v5 offset:4480
    v_pk_mul_f32 v[16:17], v[40:41], v[26:27] op_sel:[1,1] op_sel_hi:[1,0]
    v_pk_fma_f32 v[58:59], v[40:41], v[26:27], v[16:17] op_sel:[0,0,0] op_sel_hi:[0,1,1] neg_lo:[0,0,1] neg_hi:[1,0,1]
    v_cvt_pk_bf16_f32 v4, v58, v59
    v_lshlrev_b32 v8, 16, v4
    v_and_b32 v9, 0xffff0000, v4
    v_pk_add_f32 v[8:9], v[58:59], v[8:9] neg_lo:[0,1] neg_hi:[0,1]
    v_cvt_pk_bf16_f32 v5, v8, v9
    ds_write_b32 v14, v4 offset:4752
    ds_write_b32 v14, v5 offset:5008
    v_mov_b32 v58, v42
    v_sub_f32 v59, 0, v43
    v_cvt_pk_bf16_f32 v4, v58, v59
    v_lshlrev_b32 v8, 16, v4
    v_and_b32 v9, 0xffff0000, v4
    v_pk_add_f32 v[8:9], v[58:59], v[8:9] neg_lo:[0,1] neg_hi:[0,1]
    v_cvt_pk_bf16_f32 v5, v8, v9
    ds_write_b32 v14, v4 offset:5280
    ds_write_b32 v14, v5 offset:5536
    v_pk_mul_f32 v[16:17], v[42:43], v[26:27] op_sel:[1,1] op_sel_hi:[1,0]
    v_pk_fma_f32 v[58:59], v[42:43], v[26:27], v[16:17] op_sel:[0,0,0] op_sel_hi:[0,1,1] neg_lo:[0,0,1] neg_hi:[1,0,1]
    v_cvt_pk_bf16_f32 v4, v58, v59
    v_lshlrev_b32 v8, 16, v4
    v_and_b32 v9, 0xffff0000, v4
    v_pk_add_f32 v[8:9], v[58:59], v[8:9] neg_lo:[0,1] neg_hi:[0,1]
    v_cvt_pk_bf16_f32 v5, v8, v9
    ds_write_b32 v14, v4 offset:5808
    ds_write_b32 v14, v5 offset:6064
    v_mov_b32 v58, v44
    v_sub_f32 v59, 0, v45
    v_cvt_pk_bf16_f32 v4, v58, v59
    v_lshlrev_b32 v8, 16, v4
    v_and_b32 v9, 0xffff0000, v4
    v_pk_add_f32 v[8:9], v[58:59], v[8:9] neg_lo:[0,1] neg_hi:[0,1]
    v_cvt_pk_bf16_f32 v5, v8, v9
    ds_write_b32 v14, v4 offset:6336
    ds_write_b32 v14, v5 offset:6592
    v_pk_mul_f32 v[16:17], v[44:45], v[26:27] op_sel:[1,1] op_sel_hi:[1,0]
    v_pk_fma_f32 v[58:59], v[44:45], v[26:27], v[16:17] op_sel:[0,0,0] op_sel_hi:[0,1,1] neg_lo:[0,0,1] neg_hi:[1,0,1]
    v_cvt_pk_bf16_f32 v4, v58, v59
    v_lshlrev_b32 v8, 16, v4
    v_and_b32 v9, 0xffff0000, v4
    v_pk_add_f32 v[8:9], v[58:59], v[8:9] neg_lo:[0,1] neg_hi:[0,1]
    v_cvt_pk_bf16_f32 v5, v8, v9
    ds_write_b32 v14, v4 offset:6864
    ds_write_b32 v14, v5 offset:7120
    v_mov_b32 v58, v46
    v_sub_f32 v59, 0, v47
    v_cvt_pk_bf16_f32 v4, v58, v59
    v_lshlrev_b32 v8, 16, v4
    v_and_b32 v9, 0xffff0000, v4
    v_pk_add_f32 v[8:9], v[58:59], v[8:9] neg_lo:[0,1] neg_hi:[0,1]
    v_cvt_pk_bf16_f32 v5, v8, v9
    ds_write_b32 v14, v4 offset:7392
    ds_write_b32 v14, v5 offset:7648
    v_pk_mul_f32 v[16:17], v[46:47], v[26:27] op_sel:[1,1] op_sel_hi:[1,0]
    v_pk_fma_f32 v[58:59], v[46:47], v[26:27], v[16:17] op_sel:[0,0,0] op_sel_hi:[0,1,1] neg_lo:[0,0,1] neg_hi:[1,0,1]
    v_cvt_pk_bf16_f32 v4, v58, v59
    v_lshlrev_b32 v8, 16, v4
    v_and_b32 v9, 0xffff0000, v4
    v_pk_add_f32 v[8:9], v[58:59], v[8:9] neg_lo:[0,1] neg_hi:[0,1]
    v_cvt_pk_bf16_f32 v5, v8, v9
    ds_write_b32 v14, v4 offset:7920
    ds_write_b32 v14, v5 offset:8176
    s_waitcnt lgkmcnt(0)
    ds_read_b128 v[96:99], v15 offset:0
    ds_read_b128 v[100:103], v15 offset:64
    ds_read_b128 v[104:107], v15 offset:128
    ds_read_b128 v[108:111], v15 offset:192
    s_waitcnt lgkmcnt(3)
    v_mfma_f32_16x16x32_bf16 v[116:119], v[96:99], v[64:67], v[116:119]
    v_mfma_f32_16x16x32_bf16 v[116:119], v[96:99], v[80:83], v[116:119]
    s_waitcnt lgkmcnt(2)
    v_mfma_f32_16x16x32_bf16 v[116:119], v[100:103], v[68:71], v[116:119]
    v_mfma_f32_16x16x32_bf16 v[116:119], v[100:103], v[84:87], v[116:119]
    s_waitcnt lgkmcnt(1)
    v_mfma_f32_16x16x32_bf16 v[116:119], v[104:107], v[72:75], v[116:119]
    v_mfma_f32_16x16x32_bf16 v[116:119], v[104:107], v[88:91], v[116:119]
    s_waitcnt lgkmcnt(0)
    v_mfma_f32_16x16x32_bf16 v[116:119], v[108:111], v[76:79], v[116:119]
    v_mfma_f32_16x16x32_bf16 v[116:119], v[108:111], v[92:95], v[116:119]
    ds_read_b128 v[96:99], v15 offset:256
    ds_read_b128 v[100:103], v15 offset:320
    ds_read_b128 v[104:107], v15 offset:384
    ds_read_b128 v[108:111], v15 offset:448
    s_waitcnt lgkmcnt(3)
    v_mfma_f32_16x16x32_bf16 v[116:119], v[96:99], v[64:67], v[116:119]
    s_waitcnt lgkmcnt(2)
    v_mfma_f32_16x16x32_bf16 v[116:119], v[100:103], v[68:71], v[116:119]
    s_waitcnt lgkmcnt(1)
    v_mfma_f32_16x16x32_bf16 v[116:119], v[104:107], v[72:75], v[116:119]
    s_waitcnt lgkmcnt(0)
    v_mfma_f32_16x16x32_bf16 v[116:119], v[108:111], v[76:79], v[116:119]
    s_waitcnt lgkmcnt(0)
    v_mov_b32 v58, v6
    v_sub_f32 v59, 0, v7
    v_cvt_pk_bf16_f32 v4, v58, v59
    v_lshlrev_b32 v8, 16, v4
    v_and_b32 v9, 0xffff0000, v4
    v_pk_add_f32 v[8:9], v[58:59], v[8:9] neg_lo:[0,1] neg_hi:[0,1]
    v_cvt_pk_bf16_f32 v5, v8, v9
    ds_write_b32 v14, v4 offset:0
    ds_write_b32 v14, v5 offset:256
    v_pk_mul_f32 v[16:17], v[6:7], v[20:21] op_sel:[1,1] op_sel_hi:[1,0]
    v_pk_fma_f32 v[58:59], v[6:7], v[20:21], v[16:17] op_sel:[0,0,0] op_sel_hi:[0,1,1] neg_lo:[0,0,1] neg_hi:[1,0,1]
    v_cvt_pk_bf16_f32 v4, v58, v59
    v_lshlrev_b32 v8, 16, v4
    v_and_b32 v9, 0xffff0000, v4
    v_pk_add_f32 v[8:9], v[58:59], v[8:9] neg_lo:[0,1] neg_hi:[0,1]
    v_cvt_pk_bf16_f32 v5, v8, v9
    ds_write_b32 v14, v4 offset:528
    ds_write_b32 v14, v5 offset:784
    v_pk_mul_f32 v[16:17], v[6:7], v[22:23] op_sel:[1,1] op_sel_hi:[1,0]
    v_pk_fma_f32 v[58:59], v[6:7], v[22:23], v[16:17] op_sel:[0,0,0] op_sel_hi:[0,1,1] neg_lo:[0,0,1] neg_hi:[1,0,1]
    v_cvt_pk_bf16_f32 v4, v58, v59
    v_lshlrev_b32 v8, 16, v4
    v_and_b32 v9, 0xffff0000, v4
    v_pk_add_f32 v[8:9], v[58:59], v[8:9] neg_lo:[0,1] neg_hi:[0,1]
    v_cvt_pk_bf16_f32 v5, v8, v9
    ds_write_b32 v14, v4 offset:1056
    ds_write_b32 v14, v5 offset:1312
    v_pk_mul_f32 v[16:17], v[6:7], v[24:25] op_sel:[1,1] op_sel_hi:[1,0]
    v_pk_fma_f32 v[58:59], v[6:7], v[24:25], v[16:17] op_sel:[0,0,0] op_sel_hi:[0,1,1] neg_lo:[0,0,1] neg_hi:[1,0,1]
    v_cvt_pk_bf16_f32 v4, v58, v59
    v_lshlrev_b32 v8, 16, v4
    v_and_b32 v9, 0xffff0000, v4
    v_pk_add_f32 v[8:9], v[58:59], v[8:9] neg_lo:[0,1] neg_hi:[0,1]
    v_cvt_pk_bf16_f32 v5, v8, v9
    ds_write_b32 v14, v4 offset:1584
    ds_write_b32 v14, v5 offset:1840
    v_pk_mul_f32 v[16:17], v[6:7], v[26:27] op_sel:[1,1] op_sel_hi:[1,0]
    v_pk_fma_f32 v[58:59], v[6:7], v[26:27], v[16:17] op_sel:[0,0,0] op_sel_hi:[0,1,1] neg_lo:[0,0,1] neg_hi:[1,0,1]
    v_cvt_pk_bf16_f32 v4, v58, v59
    v_lshlrev_b32 v8, 16, v4
    v_and_b32 v9, 0xffff0000, v4
    v_pk_add_f32 v[8:9], v[58:59], v[8:9] neg_lo:[0,1] neg_hi:[0,1]
    v_cvt_pk_bf16_f32 v5, v8, v9
    ds_write_b32 v14, v4 offset:2112
    ds_write_b32 v14, v5 offset:2368
    v_pk_mul_f32 v[16:17], v[6:7], v[28:29] op_sel:[1,1] op_sel_hi:[1,0]
    v_pk_fma_f32 v[58:59], v[6:7], v[28:29], v[16:17] op_sel:[0,0,0] op_sel_hi:[0,1,1] neg_lo:[0,0,1] neg_hi:[1,0,1]
    v_cvt_pk_bf16_f32 v4, v58, v59
    v_lshlrev_b32 v8, 16, v4
    v_and_b32 v9, 0xffff0000, v4
    v_pk_add_f32 v[8:9], v[58:59], v[8:9] neg_lo:[0,1] neg_hi:[0,1]
    v_cvt_pk_bf16_f32 v5, v8, v9
    ds_write_b32 v14, v4 offset:2640
    ds_write_b32 v14, v5 offset:2896
    v_pk_mul_f32 v[16:17], v[6:7], v[30:31] op_sel:[1,1] op_sel_hi:[1,0]
    v_pk_fma_f32 v[58:59], v[6:7], v[30:31], v[16:17] op_sel:[0,0,0] op_sel_hi:[0,1,1] neg_lo:[0,0,1] neg_hi:[1,0,1]
    v_cvt_pk_bf16_f32 v4, v58, v59
    v_lshlrev_b32 v8, 16, v4
    v_and_b32 v9, 0xffff0000, v4
    v_pk_add_f32 v[8:9], v[58:59], v[8:9] neg_lo:[0,1] neg_hi:[0,1]
    v_cvt_pk_bf16_f32 v5, v8, v9
    ds_write_b32 v14, v4 offset:3168
    ds_write_b32 v14, v5 offset:3424
    v_pk_mul_f32 v[16:17], v[6:7], v[32:33] op_sel:[1,1] op_sel_hi:[1,0]
    v_pk_fma_f32 v[58:59], v[6:7], v[32:33], v[16:17] op_sel:[0,0,0] op_sel_hi:[0,1,1] neg_lo:[0,0,1] neg_hi:[1,0,1]
    v_cvt_pk_bf16_f32 v4, v58, v59
    v_lshlrev_b32 v8, 16, v4
    v_and_b32 v9, 0xffff0000, v4
    v_pk_add_f32 v[8:9], v[58:59], v[8:9] neg_lo:[0,1] neg_hi:[0,1]
    v_cvt_pk_bf16_f32 v5, v8, v9
    ds_write_b32 v14, v4 offset:3696
    ds_write_b32 v14, v5 offset:3952
    v_mov_b32 v58, v34
    v_sub_f32 v59, 0, v35
    v_cvt_pk_bf16_f32 v4, v58, v59
    v_lshlrev_b32 v8, 16, v4
    v_and_b32 v9, 0xffff0000, v4
    v_pk_add_f32 v[8:9], v[58:59], v[8:9] neg_lo:[0,1] neg_hi:[0,1]
    v_cvt_pk_bf16_f32 v5, v8, v9
    ds_write_b32 v14, v4 offset:4224
    ds_write_b32 v14, v5 offset:4480
    v_pk_mul_f32 v[16:17], v[34:35], v[20:21] op_sel:[1,1] op_sel_hi:[1,0]
    v_pk_fma_f32 v[58:59], v[34:35], v[20:21], v[16:17] op_sel:[0,0,0] op_sel_hi:[0,1,1] neg_lo:[0,0,1] neg_hi:[1,0,1]
    v_cvt_pk_bf16_f32 v4, v58, v59
    v_lshlrev_b32 v8, 16, v4
    v_and_b32 v9, 0xffff0000, v4
    v_pk_add_f32 v[8:9], v[58:59], v[8:9] neg_lo:[0,1] neg_hi:[0,1]
    v_cvt_pk_bf16_f32 v5, v8, v9
    ds_write_b32 v14, v4 offset:4752
    ds_write_b32 v14, v5 offset:5008
    v_pk_mul_f32 v[16:17], v[34:35], v[22:23] op_sel:[1,1] op_sel_hi:[1,0]
    v_pk_fma_f32 v[58:59], v[34:35], v[22:23], v[16:17] op_sel:[0,0,0] op_sel_hi:[0,1,1] neg_lo:[0,0,1] neg_hi:[1,0,1]
    v_cvt_pk_bf16_f32 v4, v58, v59
    v_lshlrev_b32 v8, 16, v4
    v_and_b32 v9, 0xffff0000, v4
    v_pk_add_f32 v[8:9], v[58:59], v[8:9] neg_lo:[0,1] neg_hi:[0,1]
    v_cvt_pk_bf16_f32 v5, v8, v9
    ds_write_b32 v14, v4 offset:5280
    ds_write_b32 v14, v5 offset:5536
    v_pk_mul_f32 v[16:17], v[34:35], v[24:25] op_sel:[1,1] op_sel_hi:[1,0]
    v_pk_fma_f32 v[58:59], v[34:35], v[24:25], v[16:17] op_sel:[0,0,0] op_sel_hi:[0,1,1] neg_lo:[0,0,1] neg_hi:[1,0,1]
    v_cvt_pk_bf16_f32 v4, v58, v59
    v_lshlrev_b32 v8, 16, v4
    v_and_b32 v9, 0xffff0000, v4
    v_pk_add_f32 v[8:9], v[58:59], v[8:9] neg_lo:[0,1] neg_hi:[0,1]
    v_cvt_pk_bf16_f32 v5, v8, v9
    ds_write_b32 v14, v4 offset:5808
    ds_write_b32 v14, v5 offset:6064
    v_pk_mul_f32 v[16:17], v[34:35], v[26:27] op_sel:[1,1] op_sel_hi:[1,0]
    v_pk_fma_f32 v[58:59], v[34:35], v[26:27], v[16:17] op_sel:[0,0,0] op_sel_hi:[0,1,1] neg_lo:[0,0,1] neg_hi:[1,0,1]
    v_cvt_pk_bf16_f32 v4, v58, v59
    v_lshlrev_b32 v8, 16, v4
    v_and_b32 v9, 0xffff0000, v4
    v_pk_add_f32 v[8:9], v[58:59], v[8:9] neg_lo:[0,1] neg_hi:[0,1]
    v_cvt_pk_bf16_f32 v5, v8, v9
    ds_write_b32 v14, v4 offset:6336
    ds_write_b32 v14, v5 offset:6592
    v_pk_mul_f32 v[16:17], v[34:35], v[28:29] op_sel:[1,1] op_sel_hi:[1,0]
    v_pk_fma_f32 v[58:59], v[34:35], v[28:29], v[16:17] op_sel:[0,0,0] op_sel_hi:[0,1,1] neg_lo:[0,0,1] neg_hi:[1,0,1]
    v_cvt_pk_bf16_f32 v4, v58, v59
    v_lshlrev_b32 v8, 16, v4
    v_and_b32 v9, 0xffff0000, v4
    v_pk_add_f32 v[8:9], v[58:59], v[8:9] neg_lo:[0,1] neg_hi:[0,1]
    v_cvt_pk_bf16_f32 v5, v8, v9
    ds_write_b32 v14, v4 offset:6864
    ds_write_b32 v14, v5 offset:7120
    v_pk_mul_f32 v[16:17], v[34:35], v[30:31] op_sel:[1,1] op_sel_hi:[1,0]
    v_pk_fma_f32 v[58:59], v[34:35], v[30:31], v[16:17] op_sel:[0,0,0] op_sel_hi:[0,1,1] neg_lo:[0,0,1] neg_hi:[1,0,1]
    v_cvt_pk_bf16_f32 v4, v58, v59
    v_lshlrev_b32 v8, 16, v4
    v_and_b32 v9, 0xffff0000, v4
    v_pk_add_f32 v[8:9], v[58:59], v[8:9] neg_lo:[0,1] neg_hi:[0,1]
    v_cvt_pk_bf16_f32 v5, v8, v9
    ds_write_b32 v14, v4 offset:7392
    ds_write_b32 v14, v5 offset:7648
    v_pk_mul_f32 v[16:17], v[34:35], v[32:33] op_sel:[1,1] op_sel_hi:[1,0]
    v_pk_fma_f32 v[58:59], v[34:35], v[32:33], v[16:17] op_sel:[0,0,0] op_sel_hi:[0,1,1] neg_lo:[0,0,1] neg_hi:[1,0,1]
    v_cvt_pk_bf16_f32 v4, v58, v59
    v_lshlrev_b32 v8, 16, v4
    v_and_b32 v9, 0xffff0000, v4
    v_pk_add_f32 v[8:9], v[58:59], v[8:9] neg_lo:[0,1] neg_hi:[0,1]
    v_cvt_pk_bf16_f32 v5, v8, v9
    ds_write_b32 v14, v4 offset:7920
    ds_write_b32 v14, v5 offset:8176
    s_waitcnt lgkmcnt(0)
    ds_read_b128 v[96:99], v15 offset:0
    ds_read_b128 v[100:103], v15 offset:64
    ds_read_b128 v[104:107], v15 offset:128
    ds_read_b128 v[108:111], v15 offset:192
    s_waitcnt lgkmcnt(3)
    v_mfma_f32_16x16x32_bf16 v[112:115], v[96:99], v[64:67], v[112:115]
    v_mfma_f32_16x16x32_bf16 v[112:115], v[96:99], v[80:83], v[112:115]
    s_waitcnt lgkmcnt(2)
    v_mfma_f32_16x16x32_bf16 v[112:115], v[100:103], v[68:71], v[112:115]
    v_mfma_f32_16x16x32_bf16 v[112:115], v[100:103], v[84:87], v[112:115]
    s_waitcnt lgkmcnt(1)
    v_mfma_f32_16x16x32_bf16 v[112:115], v[104:107], v[72:75], v[112:115]
    v_mfma_f32_16x16x32_bf16 v[112:115], v[104:107], v[88:91], v[112:115]
    s_waitcnt lgkmcnt(0)
    v_mfma_f32_16x16x32_bf16 v[112:115], v[108:111], v[76:79], v[112:115]
    v_mfma_f32_16x16x32_bf16 v[112:115], v[108:111], v[92:95], v[112:115]
    ds_read_b128 v[96:99], v15 offset:256
    ds_read_b128 v[100:103], v15 offset:320
    ds_read_b128 v[104:107], v15 offset:384
    ds_read_b128 v[108:111], v15 offset:448
    s_waitcnt lgkmcnt(3)
    v_mfma_f32_16x16x32_bf16 v[112:115], v[96:99], v[64:67], v[112:115]
    s_waitcnt lgkmcnt(2)
    v_mfma_f32_16x16x32_bf16 v[112:115], v[100:103], v[68:71], v[112:115]
    s_waitcnt lgkmcnt(1)
    v_mfma_f32_16x16x32_bf16 v[112:115], v[104:107], v[72:75], v[112:115]
    s_waitcnt lgkmcnt(0)
    v_mfma_f32_16x16x32_bf16 v[112:115], v[108:111], v[76:79], v[112:115]
    s_nop 15
    s_barrier
    v_mul_u32_u24 v16, 33792, v3
    v_and_b32 v17, 3, v0
    v_mul_u32_u24 v18, 3072, v17
    v_add_u32 v18, v18, v16
    v_lshl_add_u32 v18, v1, 4, v18
    ds_write_b128 v18, v[112:115] offset:0
    ds_write_b128 v18, v[116:119] offset:1024
    ds_write_b128 v18, v[120:123] offset:2048
    s_waitcnt lgkmcnt(0)
    s_barrier
    v_readfirstlane_b32 s28, v17
    s_nop 3
    s_cmp_ge_u32 s28, 3
    s_cbranch_scc1 L_kg_skip_1
    v_lshlrev_b32 v18, 10, v17
    v_add_u32 v18, v18, v16
    v_lshl_add_u32 v18, v1, 4, v18
    ds_read_b128 v[20:23], v18 offset:0
    ds_read_b128 v[24:27], v18 offset:3072
    ds_read_b128 v[28:31], v18 offset:6144
    ds_read_b128 v[32:35], v18 offset:9216
    s_waitcnt lgkmcnt(0)
    v_add_f32 v20, v20, v24
    v_add_f32 v28, v28, v32
    v_add_f32 v20, v20, v28
    v_add_f32 v21, v21, v25
    v_add_f32 v29, v29, v33
    v_add_f32 v21, v21, v29
    v_add_f32 v22, v22, v26
    v_add_f32 v30, v30, v34
    v_add_f32 v22, v22, v30
    v_add_f32 v23, v23, v27
    v_add_f32 v31, v31, v35
    v_add_f32 v23, v23, v31
    v_lshrrev_b32 v4, 4, v1
    v_and_b32 v5, 15, v1
    v_lshlrev_b32 v5, 5, v5
    v_add_u32 v5, v5, v16
    s_cmp_eq_u32 s28, 1
    s_cbranch_scc1 L_kg_t1_2
    s_cmp_eq_u32 s28, 2
    s_cbranch_scc1 L_kg_t2_3
    v_lshrrev_b32 v6, 1, v4
    v_lshlrev_b32 v6, 7, v6
    v_and_b32 v7, 1, v4
    v_lshl_add_u32 v6, v7, 2, v6
    v_lshl_add_u32 v6, v6, 2, v5
    ds_write_b32 v6, v20 offset:12288
    ds_write_b32 v6, v21 offset:12292
    ds_write_b32 v6, v22 offset:12296
    ds_write_b32 v6, v23 offset:12300
    s_branch L_kg_td_4
L_kg_t1_2:
    v_lshlrev_b32 v6, 7, v4
    v_add_u32 v6, 256, v6
    v_lshlrev_b32 v7, 8, v4
    v_cmp_gt_u32 vcc, 2, v4
    s_nop 1
    v_add_u32 v8, 0, v6
    v_add_u32 v9, 0, v7
    v_cndmask_b32 v8, v9, v8, vcc
    v_lshl_add_u32 v8, v8, 2, v5
    ds_write_b32 v8, v20 offset:12288
    v_add_u32 v8, 2, v6
    v_add_u32 v9, 4, v7
    v_cndmask_b32 v8, v9, v8, vcc
    v_lshl_add_u32 v8, v8, 2, v5
    ds_write_b32 v8, v21 offset:12288
    v_add_u32 v8, 4, v6
    v_add_u32 v9, 128, v7
    v_cndmask_b32 v8, v9, v8, vcc
    v_lshl_add_u32 v8, v8, 2, v5
    ds_write_b32 v8, v22 offset:12288
    v_add_u32 v8, 6, v6
    v_add_u32 v9, 132, v7
    v_cndmask_b32 v8, v9, v8, vcc
    v_lshl_add_u32 v8, v8, 2, v5
    ds_write_b32 v8, v23 offset:12288
    s_branch L_kg_td_4
L_kg_t2_3:
    v_lshlrev_b32 v6, 9, v4
    v_add_u32 v6, 1024, v6
    v_add_u32 v8, 0, v6
    v_min_u32 v8, 2176, v8
    v_lshl_add_u32 v8, v8, 2, v5
    ds_write_b32 v8, v20 offset:12288
    v_add_u32 v8, 128, v6
    v_min_u32 v8, 2176, v8
    v_lshl_add_u32 v8, v8, 2, v5
    ds_write_b32 v8, v21 offset:12288
    v_add_u32 v8, 256, v6
    v_min_u32 v8, 2176, v8
    v_lshl_add_u32 v8, v8, 2, v5
    ds_write_b32 v8, v22 offset:12288
    v_add_u32 v8, 384, v6
    v_min_u32 v8, 2176, v8
    v_lshl_add_u32 v8, v8, 2, v5
    ds_write_b32 v8, v23 offset:12288
L_kg_td_4:
L_kg_skip_1:
    s_waitcnt lgkmcnt(0)
    s_barrier
    v_lshl_add_u32 v18, v17, 6, v1
    v_lshlrev_b32 v19, 3, v18
    v_sub_u32 v19, 2047, v19
    v_subrev_u32 v4, 0, v19
    v_cvt_f32_u32 v4, v4
    v_cvt_pk_bf16_f32 v4, v4, v4
    v_lshlrev_b32 v4, 16, v4
    v_cvt_u32_f32 v4, v4
    v_lshl_add_u32 v4, v4, 2, v16
    ds_read_b32 v20, v4 offset:12288
    v_subrev_u32 v4, 1, v19
    v_cvt_f32_u32 v4, v4
    v_cvt_pk_bf16_f32 v4, v4, v4
    v_lshlrev_b32 v4, 16, v4
    v_cvt_u32_f32 v4, v4
    v_lshl_add_u32 v4, v4, 2, v16
    ds_read_b32 v21, v4 offset:12288
    v_subrev_u32 v4, 2, v19
    v_cvt_f32_u32 v4, v4
    v_cvt_pk_bf16_f32 v4, v4, v4
    v_lshlrev_b32 v4, 16, v4
    v_cvt_u32_f32 v4, v4
    v_lshl_add_u32 v4, v4, 2, v16
    ds_read_b32 v22, v4 offset:12288
    v_subrev_u32 v4, 3, v19
    v_cvt_f32_u32 v4, v4
    v_cvt_pk_bf16_f32 v4, v4, v4
    v_lshlrev_b32 v4, 16, v4
    v_cvt_u32_f32 v4, v4
    v_lshl_add_u32 v4, v4, 2, v16
    ds_read_b32 v23, v4 offset:12288
    v_subrev_u32 v4, 4, v19
    v_cvt_f32_u32 v4, v4
    v_cvt_pk_bf16_f32 v4, v4, v4
    v_lshlrev_b32 v4, 16, v4
    v_cvt_u32_f32 v4, v4
    v_lshl_add_u32 v4, v4, 2, v16
    ds_read_b32 v24, v4 offset:12288
    v_subrev_u32 v4, 5, v19
    v_cvt_f32_u32 v4, v4
    v_cvt_pk_bf16_f32 v4, v4, v4
    v_lshlrev_b32 v4, 16, v4
    v_cvt_u32_f32 v4, v4
    v_lshl_add_u32 v4, v4, 2, v16
    ds_read_b32 v25, v4 offset:12288
    v_subrev_u32 v4, 6, v19
    v_cvt_f32_u32 v4, v4
    v_cvt_pk_bf16_f32 v4, v4, v4
    v_lshlrev_b32 v4, 16, v4
    v_cvt_u32_f32 v4, v4
    v_lshl_add_u32 v4, v4, 2, v16
    ds_read_b32 v26, v4 offset:12288
    v_subrev_u32 v4, 7, v19
    v_cvt_f32_u32 v4, v4
    v_cvt_pk_bf16_f32 v4, v4, v4
    v_lshlrev_b32 v4, 16, v4
    v_cvt_u32_f32 v4, v4
    v_lshl_add_u32 v4, v4, 2, v16
    ds_read_b32 v27, v4 offset:12288
    v_mul_u32_u24 v5, 4224, v2
    v_lshl_add_u32 v5, v18, 4, v5
    s_waitcnt lgkmcnt(0)
    v_cvt_pk_bf16_f32 v28, v20, v21
    v_cvt_pk_bf16_f32 v29, v22, v23
    v_cvt_pk_bf16_f32 v30, v24, v25
    v_cvt_pk_bf16_f32 v31, v26, v27
    buffer_store_dwordx4 v[28:31], v5, s[44:47], 0 offen sc1
    v_mov_b32 v32, 0
    v_mov_b32 v33, 0
    v_mov_b32 v34, 0
    v_mov_b32 v35, 0
    v_cmp_gt_u32 vcc, 8, v18
    s_and_saveexec_b64 s[48:49], vcc
    s_cbranch_execz L_kg_z_5
    s_mov_b32 s28, 4096
    buffer_store_dwordx4 v[32:35], v5, s[44:47], s28 offen
L_kg_z_5:
    s_endpgm
ka_kernel_ln:
    s_sub_u32 s3, s2, 224
    s_cmp_lg_u32 s3, 0
    s_cbranch_scc1 L_k0_z_6
    s_add_u32 s52, s6, 18874368
    s_addc_u32 s53, s7, 0
    s_mov_b32 s54, 24576
    s_mov_b32 s55, 0x00020000
    v_lshlrev_b32 v4, 4, v0
    v_mov_b32 v8, 0
    v_mov_b32 v9, 0
    v_mov_b32 v10, 0
    v_mov_b32 v11, 0
    buffer_store_dwordx4 v[8:11], v4, s[52:55], 0 offen
    s_mov_b32 s26, 8192
    buffer_store_dwordx4 v[8:11], v4, s[52:55], s26 offen
    s_mov_b32 s26, 16384
    buffer_store_dwordx4 v[8:11], v4, s[52:55], s26 offen
L_k0_z_6:
    s_setprio 3
    s_mov_b32 s8, s4
    s_mov_b32 s9, s5
    s_mov_b32 s10, 1835008
    s_mov_b32 s11, 0x00020000
    s_add_u32 s16, s6, 2097152
    s_addc_u32 s17, s7, 0
    s_mov_b32 s18, 1835008
    s_mov_b32 s19, 0x00020000
    v_lshrrev_b32 v2, 3, v0
    v_and_b32 v3, 7, v0
    s_lshl_b32 s20, s3, 6
    v_add_u32 v4, s20, v2
    v_mul_u32_u24 v1, 896, v4
    v_lshl_add_u32 v1, v3, 4, v1

    buffer_load_dwordx4 v[16:19], v1, s[8:11], 0 offen offset:0
    buffer_load_dwordx4 v[20:23], v1, s[8:11], 0 offen offset:128
    buffer_load_dwordx4 v[24:27], v1, s[8:11], 0 offen offset:256
    buffer_load_dwordx4 v[28:31], v1, s[8:11], 0 offen offset:384
    buffer_load_dwordx4 v[32:35], v1, s[8:11], 0 offen offset:512
    buffer_load_dwordx4 v[36:39], v1, s[8:11], 0 offen offset:640
    buffer_load_dwordx4 v[40:43], v1, s[8:11], 0 offen offset:768
    v_mov_b32 v5, 0x3f803f80
    v_mov_b32 v6, 0
    v_mov_b32 v7, 0
    s_waitcnt vmcnt(0)
    v_dot2_f32_bf16 v6, v16, v5, v6
    v_dot2_f32_bf16 v7, v17, v5, v7
    v_dot2_f32_bf16 v6, v18, v5, v6
    v_dot2_f32_bf16 v7, v19, v5, v7
    v_dot2_f32_bf16 v6, v20, v5, v6
    v_dot2_f32_bf16 v7, v21, v5, v7
    v_dot2_f32_bf16 v6, v22, v5, v6
    v_dot2_f32_bf16 v7, v23, v5, v7
    v_dot2_f32_bf16 v6, v24, v5, v6
    v_dot2_f32_bf16 v7, v25, v5, v7
    v_dot2_f32_bf16 v6, v26, v5, v6
    v_dot2_f32_bf16 v7, v27, v5, v7
    v_dot2_f32_bf16 v6, v28, v5, v6
    v_dot2_f32_bf16 v7, v29, v5, v7
    v_dot2_f32_bf16 v6, v30, v5, v6
    v_dot2_f32_bf16 v7, v31, v5, v7
    v_dot2_f32_bf16 v6, v32, v5, v6
    v_dot2_f32_bf16 v7, v33, v5, v7
    v_dot2_f32_bf16 v6, v34, v5, v6
    v_dot2_f32_bf16 v7, v35, v5, v7
    v_dot2_f32_bf16 v6, v36, v5, v6
    v_dot2_f32_bf16 v7, v37, v5, v7
    v_dot2_f32_bf16 v6, v38, v5, v6
    v_dot2_f32_bf16 v7, v39, v5, v7
    v_dot2_f32_bf16 v6, v40, v5, v6
    v_dot2_f32_bf16 v7, v41, v5, v7
    v_dot2_f32_bf16 v6, v42, v5, v6
    v_dot2_f32_bf16 v7, v43, v5, v7
    s_nop 3
    v_add_f32 v6, v6, v7
    s_nop 1
    v_add_f32_dpp v6, v6, v6 quad_perm:[1,0,3,2] row_mask:0xf bank_mask:0xf
    s_nop 1
    v_add_f32_dpp v6, v6, v6 quad_perm:[2,3,0,1] row_mask:0xf bank_mask:0xf
    s_nop 1
    v_add_f32_dpp v6, v6, v6 row_half_mirror row_mask:0xf bank_mask:0xf
    v_mul_f32 v6, 0x3b124925, v6
    v_mov_b32 v7, v6
    v_lshlrev_b32 v44, 16, v16
    v_and_b32 v45, 0xffff0000, v16
    v_lshlrev_b32 v46, 16, v17
    v_and_b32 v47, 0xffff0000, v17
    v_lshlrev_b32 v48, 16, v18
    v_and_b32 v49, 0xffff0000, v18
    v_lshlrev_b32 v50, 16, v19
    v_and_b32 v51, 0xffff0000, v19
    v_lshlrev_b32 v52, 16, v20
    v_and_b32 v53, 0xffff0000, v20
    v_lshlrev_b32 v54, 16, v21
    v_and_b32 v55, 0xffff0000, v21
    v_lshlrev_b32 v56, 16, v22
    v_and_b32 v57, 0xffff0000, v22
    v_lshlrev_b32 v58, 16, v23
    v_and_b32 v59, 0xffff0000, v23
    v_lshlrev_b32 v60, 16, v24
    v_and_b32 v61, 0xffff0000, v24
    v_lshlrev_b32 v62, 16, v25
    v_and_b32 v63, 0xffff0000, v25
    v_lshlrev_b32 v64, 16, v26
    v_and_b32 v65, 0xffff0000, v26
    v_lshlrev_b32 v66, 16, v27
    v_and_b32 v67, 0xffff0000, v27
    v_lshlrev_b32 v68, 16, v28
    v_and_b32 v69, 0xffff0000, v28
    v_lshlrev_b32 v70, 16, v29
    v_and_b32 v71, 0xffff0000, v29
    v_lshlrev_b32 v72, 16, v30
    v_and_b32 v73, 0xffff0000, v30
    v_lshlrev_b32 v74, 16, v31
    v_and_b32 v75, 0xffff0000, v31
    v_lshlrev_b32 v76, 16, v32
    v_and_b32 v77, 0xffff0000, v32
    v_lshlrev_b32 v78, 16, v33
    v_and_b32 v79, 0xffff0000, v33
    v_lshlrev_b32 v80, 16, v34
    v_and_b32 v81, 0xffff0000, v34
    v_lshlrev_b32 v82, 16, v35
    v_and_b32 v83, 0xffff0000, v35
    v_lshlrev_b32 v84, 16, v36
    v_and_b32 v85, 0xffff0000, v36
    v_lshlrev_b32 v86, 16, v37
    v_and_b32 v87, 0xffff0000, v37
    v_lshlrev_b32 v88, 16, v38
    v_and_b32 v89, 0xffff0000, v38
    v_lshlrev_b32 v90, 16, v39
    v_and_b32 v91, 0xffff0000, v39
    v_lshlrev_b32 v92, 16, v40
    v_and_b32 v93, 0xffff0000, v40
    v_lshlrev_b32 v94, 16, v41
    v_and_b32 v95, 0xffff0000, v41
    v_lshlrev_b32 v96, 16, v42
    v_and_b32 v97, 0xffff0000, v42
    v_lshlrev_b32 v98, 16, v43
    v_and_b32 v99, 0xffff0000, v43
    v_mov_b32 v8, 0
    v_mov_b32 v9, 0
    v_pk_add_f32 v[10:11], v[44:45], v[6:7] neg_lo:[0,1] neg_hi:[0,1]
    v_pk_fma_f32 v[8:9], v[10:11], v[10:11], v[8:9]
    v_pk_add_f32 v[10:11], v[46:47], v[6:7] neg_lo:[0,1] neg_hi:[0,1]
    v_pk_fma_f32 v[8:9], v[10:11], v[10:11], v[8:9]
    v_pk_add_f32 v[10:11], v[48:49], v[6:7] neg_lo:[0,1] neg_hi:[0,1]
    v_pk_fma_f32 v[8:9], v[10:11], v[10:11], v[8:9]
    v_pk_add_f32 v[10:11], v[50:51], v[6:7] neg_lo:[0,1] neg_hi:[0,1]
    v_pk_fma_f32 v[8:9], v[10:11], v[10:11], v[8:9]
    v_pk_add_f32 v[10:11], v[52:53], v[6:7] neg_lo:[0,1] neg_hi:[0,1]
    v_pk_fma_f32 v[8:9], v[10:11], v[10:11], v[8:9]
    v_pk_add_f32 v[10:11], v[54:55], v[6:7] neg_lo:[0,1] neg_hi:[0,1]
    v_pk_fma_f32 v[8:9], v[10:11], v[10:11], v[8:9]
    v_pk_add_f32 v[10:11], v[56:57], v[6:7] neg_lo:[0,1] neg_hi:[0,1]
    v_pk_fma_f32 v[8:9], v[10:11], v[10:11], v[8:9]
    v_pk_add_f32 v[10:11], v[58:59], v[6:7] neg_lo:[0,1] neg_hi:[0,1]
    v_pk_fma_f32 v[8:9], v[10:11], v[10:11], v[8:9]
    v_pk_add_f32 v[10:11], v[60:61], v[6:7] neg_lo:[0,1] neg_hi:[0,1]
    v_pk_fma_f32 v[8:9], v[10:11], v[10:11], v[8:9]
    v_pk_add_f32 v[10:11], v[62:63], v[6:7] neg_lo:[0,1] neg_hi:[0,1]
    v_pk_fma_f32 v[8:9], v[10:11], v[10:11], v[8:9]
    v_pk_add_f32 v[10:11], v[64:65], v[6:7] neg_lo:[0,1] neg_hi:[0,1]
    v_pk_fma_f32 v[8:9], v[10:11], v[10:11], v[8:9]
    v_pk_add_f32 v[10:11], v[66:67], v[6:7] neg_lo:[0,1] neg_hi:[0,1]
    v_pk_fma_f32 v[8:9], v[10:11], v[10:11], v[8:9]
    v_pk_add_f32 v[10:11], v[68:69], v[6:7] neg_lo:[0,1] neg_hi:[0,1]
    v_pk_fma_f32 v[8:9], v[10:11], v[10:11], v[8:9]
    v_pk_add_f32 v[10:11], v[70:71], v[6:7] neg_lo:[0,1] neg_hi:[0,1]
    v_pk_fma_f32 v[8:9], v[10:11], v[10:11], v[8:9]
    v_pk_add_f32 v[10:11], v[72:73], v[6:7] neg_lo:[0,1] neg_hi:[0,1]
    v_pk_fma_f32 v[8:9], v[10:11], v[10:11], v[8:9]
    v_pk_add_f32 v[10:11], v[74:75], v[6:7] neg_lo:[0,1] neg_hi:[0,1]
    v_pk_fma_f32 v[8:9], v[10:11], v[10:11], v[8:9]
    v_pk_add_f32 v[10:11], v[76:77], v[6:7] neg_lo:[0,1] neg_hi:[0,1]
    v_pk_fma_f32 v[8:9], v[10:11], v[10:11], v[8:9]
    v_pk_add_f32 v[10:11], v[78:79], v[6:7] neg_lo:[0,1] neg_hi:[0,1]
    v_pk_fma_f32 v[8:9], v[10:11], v[10:11], v[8:9]
    v_pk_add_f32 v[10:11], v[80:81], v[6:7] neg_lo:[0,1] neg_hi:[0,1]
    v_pk_fma_f32 v[8:9], v[10:11], v[10:11], v[8:9]
    v_pk_add_f32 v[10:11], v[82:83], v[6:7] neg_lo:[0,1] neg_hi:[0,1]
    v_pk_fma_f32 v[8:9], v[10:11], v[10:11], v[8:9]
    v_pk_add_f32 v[10:11], v[84:85], v[6:7] neg_lo:[0,1] neg_hi:[0,1]
    v_pk_fma_f32 v[8:9], v[10:11], v[10:11], v[8:9]
    v_pk_add_f32 v[10:11], v[86:87], v[6:7] neg_lo:[0,1] neg_hi:[0,1]
    v_pk_fma_f32 v[8:9], v[10:11], v[10:11], v[8:9]
    v_pk_add_f32 v[10:11], v[88:89], v[6:7] neg_lo:[0,1] neg_hi:[0,1]
    v_pk_fma_f32 v[8:9], v[10:11], v[10:11], v[8:9]
    v_pk_add_f32 v[10:11], v[90:91], v[6:7] neg_lo:[0,1] neg_hi:[0,1]
    v_pk_fma_f32 v[8:9], v[10:11], v[10:11], v[8:9]
    v_pk_add_f32 v[10:11], v[92:93], v[6:7] neg_lo:[0,1] neg_hi:[0,1]
    v_pk_fma_f32 v[8:9], v[10:11], v[10:11], v[8:9]
    v_pk_add_f32 v[10:11], v[94:95], v[6:7] neg_lo:[0,1] neg_hi:[0,1]
    v_pk_fma_f32 v[8:9], v[10:11], v[10:11], v[8:9]
    v_pk_add_f32 v[10:11], v[96:97], v[6:7] neg_lo:[0,1] neg_hi:[0,1]
    v_pk_fma_f32 v[8:9], v[10:11], v[10:11], v[8:9]
    v_pk_add_f32 v[10:11], v[98:99], v[6:7] neg_lo:[0,1] neg_hi:[0,1]
    v_pk_fma_f32 v[8:9], v[10:11], v[10:11], v[8:9]
    v_add_f32 v8, v8, v9
    s_nop 1
    v_add_f32_dpp v8, v8, v8 quad_perm:[1,0,3,2] row_mask:0xf bank_mask:0xf
    s_nop 1
    v_add_f32_dpp v8, v8, v8 quad_perm:[2,3,0,1] row_mask:0xf bank_mask:0xf
    s_nop 1
    v_add_f32_dpp v8, v8, v8 row_half_mirror row_mask:0xf bank_mask:0xf
    v_mul_f32 v8, 0x3b124925, v8
    v_cvt_pk_bf16_f32 v8, v8, v8
    v_lshlrev_b32 v8, 16, v8
    v_add_f32 v8, 0x3727c5ac, v8
    v_cvt_pk_bf16_f32 v8, v8, v8
    v_lshlrev_b32 v8, 16, v8
    v_sqrt_f32 v8, v8
    s_nop 0
    v_cvt_pk_bf16_f32 v8, v8, v8
    v_lshlrev_b32 v8, 16, v8
    v_rcp_f32 v12, v8
    v_mov_b32 v9, v8
    v_cvt_pk_bf16_f32 v6, v6, v6
    v_lshlrev_b32 v6, 16, v6
    v_mov_b32 v7, v6
    v_mov_b32 v13, v12
    v_pk_add_f32 v[44:45], v[44:45], v[6:7] neg_lo:[0,1] neg_hi:[0,1]
    v_cvt_pk_bf16_f32 v10, v44, v45
    v_lshlrev_b32 v44, 16, v10
    v_and_b32 v45, 0xffff0000, v10
    v_pk_mul_f32 v[10:11], v[44:45], v[12:13]
    v_pk_fma_f32 v[44:45], v[10:11], v[8:9], v[44:45] neg_lo:[1,0,0] neg_hi:[1,0,0]
    v_pk_fma_f32 v[10:11], v[44:45], v[12:13], v[10:11]
    v_cvt_pk_bf16_f32 v16, v10, v11
    v_pk_add_f32 v[46:47], v[46:47], v[6:7] neg_lo:[0,1] neg_hi:[0,1]
    v_cvt_pk_bf16_f32 v10, v46, v47
    v_lshlrev_b32 v46, 16, v10
    v_and_b32 v47, 0xffff0000, v10
    v_pk_mul_f32 v[10:11], v[46:47], v[12:13]
    v_pk_fma_f32 v[46:47], v[10:11], v[8:9], v[46:47] neg_lo:[1,0,0] neg_hi:[1,0,0]
    v_pk_fma_f32 v[10:11], v[46:47], v[12:13], v[10:11]
    v_cvt_pk_bf16_f32 v17, v10, v11
    v_pk_add_f32 v[48:49], v[48:49], v[6:7] neg_lo:[0,1] neg_hi:[0,1]
    v_cvt_pk_bf16_f32 v10, v48, v49
    v_lshlrev_b32 v48, 16, v10
    v_and_b32 v49, 0xffff0000, v10
    v_pk_mul_f32 v[10:11], v[48:49], v[12:13]
    v_pk_fma_f32 v[48:49], v[10:11], v[8:9], v[48:49] neg_lo:[1,0,0] neg_hi:[1,0,0]
    v_pk_fma_f32 v[10:11], v[48:49], v[12:13], v[10:11]
    v_cvt_pk_bf16_f32 v18, v10, v11
    v_pk_add_f32 v[50:51], v[50:51], v[6:7] neg_lo:[0,1] neg_hi:[0,1]
    v_cvt_pk_bf16_f32 v10, v50, v51
    v_lshlrev_b32 v50, 16, v10
    v_and_b32 v51, 0xffff0000, v10
    v_pk_mul_f32 v[10:11], v[50:51], v[12:13]
    v_pk_fma_f32 v[50:51], v[10:11], v[8:9], v[50:51] neg_lo:[1,0,0] neg_hi:[1,0,0]
    v_pk_fma_f32 v[10:11], v[50:51], v[12:13], v[10:11]
    v_cvt_pk_bf16_f32 v19, v10, v11
    v_pk_add_f32 v[52:53], v[52:53], v[6:7] neg_lo:[0,1] neg_hi:[0,1]
    v_cvt_pk_bf16_f32 v10, v52, v53
    v_lshlrev_b32 v52, 16, v10
    v_and_b32 v53, 0xffff0000, v10
    v_pk_mul_f32 v[10:11], v[52:53], v[12:13]
    v_pk_fma_f32 v[52:53], v[10:11], v[8:9], v[52:53] neg_lo:[1,0,0] neg_hi:[1,0,0]
    v_pk_fma_f32 v[10:11], v[52:53], v[12:13], v[10:11]
    v_cvt_pk_bf16_f32 v20, v10, v11
    v_pk_add_f32 v[54:55], v[54:55], v[6:7] neg_lo:[0,1] neg_hi:[0,1]
    v_cvt_pk_bf16_f32 v10, v54, v55
    v_lshlrev_b32 v54, 16, v10
    v_and_b32 v55, 0xffff0000, v10
    v_pk_mul_f32 v[10:11], v[54:55], v[12:13]
    v_pk_fma_f32 v[54:55], v[10:11], v[8:9], v[54:55] neg_lo:[1,0,0] neg_hi:[1,0,0]
    v_pk_fma_f32 v[10:11], v[54:55], v[12:13], v[10:11]
    v_cvt_pk_bf16_f32 v21, v10, v11
    v_pk_add_f32 v[56:57], v[56:57], v[6:7] neg_lo:[0,1] neg_hi:[0,1]
    v_cvt_pk_bf16_f32 v10, v56, v57
    v_lshlrev_b32 v56, 16, v10
    v_and_b32 v57, 0xffff0000, v10
    v_pk_mul_f32 v[10:11], v[56:57], v[12:13]
    v_pk_fma_f32 v[56:57], v[10:11], v[8:9], v[56:57] neg_lo:[1,0,0] neg_hi:[1,0,0]
    v_pk_fma_f32 v[10:11], v[56:57], v[12:13], v[10:11]
    v_cvt_pk_bf16_f32 v22, v10, v11
    v_pk_add_f32 v[58:59], v[58:59], v[6:7] neg_lo:[0,1] neg_hi:[0,1]
    v_cvt_pk_bf16_f32 v10, v58, v59
    v_lshlrev_b32 v58, 16, v10
    v_and_b32 v59, 0xffff0000, v10
    v_pk_mul_f32 v[10:11], v[58:59], v[12:13]
    v_pk_fma_f32 v[58:59], v[10:11], v[8:9], v[58:59] neg_lo:[1,0,0] neg_hi:[1,0,0]
    v_pk_fma_f32 v[10:11], v[58:59], v[12:13], v[10:11]
    v_cvt_pk_bf16_f32 v23, v10, v11
    v_pk_add_f32 v[60:61], v[60:61], v[6:7] neg_lo:[0,1] neg_hi:[0,1]
    v_cvt_pk_bf16_f32 v10, v60, v61
    v_lshlrev_b32 v60, 16, v10
    v_and_b32 v61, 0xffff0000, v10
    v_pk_mul_f32 v[10:11], v[60:61], v[12:13]
    v_pk_fma_f32 v[60:61], v[10:11], v[8:9], v[60:61] neg_lo:[1,0,0] neg_hi:[1,0,0]
    v_pk_fma_f32 v[10:11], v[60:61], v[12:13], v[10:11]
    v_cvt_pk_bf16_f32 v24, v10, v11
    v_pk_add_f32 v[62:63], v[62:63], v[6:7] neg_lo:[0,1] neg_hi:[0,1]
    v_cvt_pk_bf16_f32 v10, v62, v63
    v_lshlrev_b32 v62, 16, v10
    v_and_b32 v63, 0xffff0000, v10
    v_pk_mul_f32 v[10:11], v[62:63], v[12:13]
    v_pk_fma_f32 v[62:63], v[10:11], v[8:9], v[62:63] neg_lo:[1,0,0] neg_hi:[1,0,0]
    v_pk_fma_f32 v[10:11], v[62:63], v[12:13], v[10:11]
    v_cvt_pk_bf16_f32 v25, v10, v11
    v_pk_add_f32 v[64:65], v[64:65], v[6:7] neg_lo:[0,1] neg_hi:[0,1]
    v_cvt_pk_bf16_f32 v10, v64, v65
    v_lshlrev_b32 v64, 16, v10
    v_and_b32 v65, 0xffff0000, v10
    v_pk_mul_f32 v[10:11], v[64:65], v[12:13]
    v_pk_fma_f32 v[64:65], v[10:11], v[8:9], v[64:65] neg_lo:[1,0,0] neg_hi:[1,0,0]
    v_pk_fma_f32 v[10:11], v[64:65], v[12:13], v[10:11]
    v_cvt_pk_bf16_f32 v26, v10, v11
    v_pk_add_f32 v[66:67], v[66:67], v[6:7] neg_lo:[0,1] neg_hi:[0,1]
    v_cvt_pk_bf16_f32 v10, v66, v67
    v_lshlrev_b32 v66, 16, v10
    v_and_b32 v67, 0xffff0000, v10
    v_pk_mul_f32 v[10:11], v[66:67], v[12:13]
    v_pk_fma_f32 v[66:67], v[10:11], v[8:9], v[66:67] neg_lo:[1,0,0] neg_hi:[1,0,0]
    v_pk_fma_f32 v[10:11], v[66:67], v[12:13], v[10:11]
    v_cvt_pk_bf16_f32 v27, v10, v11
    v_pk_add_f32 v[68:69], v[68:69], v[6:7] neg_lo:[0,1] neg_hi:[0,1]
    v_cvt_pk_bf16_f32 v10, v68, v69
    v_lshlrev_b32 v68, 16, v10
    v_and_b32 v69, 0xffff0000, v10
    v_pk_mul_f32 v[10:11], v[68:69], v[12:13]
    v_pk_fma_f32 v[68:69], v[10:11], v[8:9], v[68:69] neg_lo:[1,0,0] neg_hi:[1,0,0]
    v_pk_fma_f32 v[10:11], v[68:69], v[12:13], v[10:11]
    v_cvt_pk_bf16_f32 v28, v10, v11
    v_pk_add_f32 v[70:71], v[70:71], v[6:7] neg_lo:[0,1] neg_hi:[0,1]
    v_cvt_pk_bf16_f32 v10, v70, v71
    v_lshlrev_b32 v70, 16, v10
    v_and_b32 v71, 0xffff0000, v10
    v_pk_mul_f32 v[10:11], v[70:71], v[12:13]
    v_pk_fma_f32 v[70:71], v[10:11], v[8:9], v[70:71] neg_lo:[1,0,0] neg_hi:[1,0,0]
    v_pk_fma_f32 v[10:11], v[70:71], v[12:13], v[10:11]
    v_cvt_pk_bf16_f32 v29, v10, v11
    v_pk_add_f32 v[72:73], v[72:73], v[6:7] neg_lo:[0,1] neg_hi:[0,1]
    v_cvt_pk_bf16_f32 v10, v72, v73
    v_lshlrev_b32 v72, 16, v10
    v_and_b32 v73, 0xffff0000, v10
    v_pk_mul_f32 v[10:11], v[72:73], v[12:13]
    v_pk_fma_f32 v[72:73], v[10:11], v[8:9], v[72:73] neg_lo:[1,0,0] neg_hi:[1,0,0]
    v_pk_fma_f32 v[10:11], v[72:73], v[12:13], v[10:11]
    v_cvt_pk_bf16_f32 v30, v10, v11
    v_pk_add_f32 v[74:75], v[74:75], v[6:7] neg_lo:[0,1] neg_hi:[0,1]
    v_cvt_pk_bf16_f32 v10, v74, v75
    v_lshlrev_b32 v74, 16, v10
    v_and_b32 v75, 0xffff0000, v10
    v_pk_mul_f32 v[10:11], v[74:75], v[12:13]
    v_pk_fma_f32 v[74:75], v[10:11], v[8:9], v[74:75] neg_lo:[1,0,0] neg_hi:[1,0,0]
    v_pk_fma_f32 v[10:11], v[74:75], v[12:13], v[10:11]
    v_cvt_pk_bf16_f32 v31, v10, v11
    v_pk_add_f32 v[76:77], v[76:77], v[6:7] neg_lo:[0,1] neg_hi:[0,1]
    v_cvt_pk_bf16_f32 v10, v76, v77
    v_lshlrev_b32 v76, 16, v10
    v_and_b32 v77, 0xffff0000, v10
    v_pk_mul_f32 v[10:11], v[76:77], v[12:13]
    v_pk_fma_f32 v[76:77], v[10:11], v[8:9], v[76:77] neg_lo:[1,0,0] neg_hi:[1,0,0]
    v_pk_fma_f32 v[10:11], v[76:77], v[12:13], v[10:11]
    v_cvt_pk_bf16_f32 v32, v10, v11
    v_pk_add_f32 v[78:79], v[78:79], v[6:7] neg_lo:[0,1] neg_hi:[0,1]
    v_cvt_pk_bf16_f32 v10, v78, v79
    v_lshlrev_b32 v78, 16, v10
    v_and_b32 v79, 0xffff0000, v10
    v_pk_mul_f32 v[10:11], v[78:79], v[12:13]
    v_pk_fma_f32 v[78:79], v[10:11], v[8:9], v[78:79] neg_lo:[1,0,0] neg_hi:[1,0,0]
    v_pk_fma_f32 v[10:11], v[78:79], v[12:13], v[10:11]
    v_cvt_pk_bf16_f32 v33, v10, v11
    v_pk_add_f32 v[80:81], v[80:81], v[6:7] neg_lo:[0,1] neg_hi:[0,1]
    v_cvt_pk_bf16_f32 v10, v80, v81
    v_lshlrev_b32 v80, 16, v10
    v_and_b32 v81, 0xffff0000, v10
    v_pk_mul_f32 v[10:11], v[80:81], v[12:13]
    v_pk_fma_f32 v[80:81], v[10:11], v[8:9], v[80:81] neg_lo:[1,0,0] neg_hi:[1,0,0]
    v_pk_fma_f32 v[10:11], v[80:81], v[12:13], v[10:11]
    v_cvt_pk_bf16_f32 v34, v10, v11
    v_pk_add_f32 v[82:83], v[82:83], v[6:7] neg_lo:[0,1] neg_hi:[0,1]
    v_cvt_pk_bf16_f32 v10, v82, v83
    v_lshlrev_b32 v82, 16, v10
    v_and_b32 v83, 0xffff0000, v10
    v_pk_mul_f32 v[10:11], v[82:83], v[12:13]
    v_pk_fma_f32 v[82:83], v[10:11], v[8:9], v[82:83] neg_lo:[1,0,0] neg_hi:[1,0,0]
    v_pk_fma_f32 v[10:11], v[82:83], v[12:13], v[10:11]
    v_cvt_pk_bf16_f32 v35, v10, v11
    v_pk_add_f32 v[84:85], v[84:85], v[6:7] neg_lo:[0,1] neg_hi:[0,1]
    v_cvt_pk_bf16_f32 v10, v84, v85
    v_lshlrev_b32 v84, 16, v10
    v_and_b32 v85, 0xffff0000, v10
    v_pk_mul_f32 v[10:11], v[84:85], v[12:13]
    v_pk_fma_f32 v[84:85], v[10:11], v[8:9], v[84:85] neg_lo:[1,0,0] neg_hi:[1,0,0]
    v_pk_fma_f32 v[10:11], v[84:85], v[12:13], v[10:11]
    v_cvt_pk_bf16_f32 v36, v10, v11
    v_pk_add_f32 v[86:87], v[86:87], v[6:7] neg_lo:[0,1] neg_hi:[0,1]
    v_cvt_pk_bf16_f32 v10, v86, v87
    v_lshlrev_b32 v86, 16, v10
    v_and_b32 v87, 0xffff0000, v10
    v_pk_mul_f32 v[10:11], v[86:87], v[12:13]
    v_pk_fma_f32 v[86:87], v[10:11], v[8:9], v[86:87] neg_lo:[1,0,0] neg_hi:[1,0,0]
    v_pk_fma_f32 v[10:11], v[86:87], v[12:13], v[10:11]
    v_cvt_pk_bf16_f32 v37, v10, v11
    v_pk_add_f32 v[88:89], v[88:89], v[6:7] neg_lo:[0,1] neg_hi:[0,1]
    v_cvt_pk_bf16_f32 v10, v88, v89
    v_lshlrev_b32 v88, 16, v10
    v_and_b32 v89, 0xffff0000, v10
    v_pk_mul_f32 v[10:11], v[88:89], v[12:13]
    v_pk_fma_f32 v[88:89], v[10:11], v[8:9], v[88:89] neg_lo:[1,0,0] neg_hi:[1,0,0]
    v_pk_fma_f32 v[10:11], v[88:89], v[12:13], v[10:11]
    v_cvt_pk_bf16_f32 v38, v10, v11
    v_pk_add_f32 v[90:91], v[90:91], v[6:7] neg_lo:[0,1] neg_hi:[0,1]
    v_cvt_pk_bf16_f32 v10, v90, v91
    v_lshlrev_b32 v90, 16, v10
    v_and_b32 v91, 0xffff0000, v10
    v_pk_mul_f32 v[10:11], v[90:91], v[12:13]
    v_pk_fma_f32 v[90:91], v[10:11], v[8:9], v[90:91] neg_lo:[1,0,0] neg_hi:[1,0,0]
    v_pk_fma_f32 v[10:11], v[90:91], v[12:13], v[10:11]
    v_cvt_pk_bf16_f32 v39, v10, v11
    v_pk_add_f32 v[92:93], v[92:93], v[6:7] neg_lo:[0,1] neg_hi:[0,1]
    v_cvt_pk_bf16_f32 v10, v92, v93
    v_lshlrev_b32 v92, 16, v10
    v_and_b32 v93, 0xffff0000, v10
    v_pk_mul_f32 v[10:11], v[92:93], v[12:13]
    v_pk_fma_f32 v[92:93], v[10:11], v[8:9], v[92:93] neg_lo:[1,0,0] neg_hi:[1,0,0]
    v_pk_fma_f32 v[10:11], v[92:93], v[12:13], v[10:11]
    v_cvt_pk_bf16_f32 v40, v10, v11
    v_pk_add_f32 v[94:95], v[94:95], v[6:7] neg_lo:[0,1] neg_hi:[0,1]
    v_cvt_pk_bf16_f32 v10, v94, v95
    v_lshlrev_b32 v94, 16, v10
    v_and_b32 v95, 0xffff0000, v10
    v_pk_mul_f32 v[10:11], v[94:95], v[12:13]
    v_pk_fma_f32 v[94:95], v[10:11], v[8:9], v[94:95] neg_lo:[1,0,0] neg_hi:[1,0,0]
    v_pk_fma_f32 v[10:11], v[94:95], v[12:13], v[10:11]
    v_cvt_pk_bf16_f32 v41, v10, v11
    v_pk_add_f32 v[96:97], v[96:97], v[6:7] neg_lo:[0,1] neg_hi:[0,1]
    v_cvt_pk_bf16_f32 v10, v96, v97
    v_lshlrev_b32 v96, 16, v10
    v_and_b32 v97, 0xffff0000, v10
    v_pk_mul_f32 v[10:11], v[96:97], v[12:13]
    v_pk_fma_f32 v[96:97], v[10:11], v[8:9], v[96:97] neg_lo:[1,0,0] neg_hi:[1,0,0]
    v_pk_fma_f32 v[10:11], v[96:97], v[12:13], v[10:11]
    v_cvt_pk_bf16_f32 v42, v10, v11
    v_pk_add_f32 v[98:99], v[98:99], v[6:7] neg_lo:[0,1] neg_hi:[0,1]
    v_cvt_pk_bf16_f32 v10, v98, v99
    v_lshlrev_b32 v98, 16, v10
    v_and_b32 v99, 0xffff0000, v10
    v_pk_mul_f32 v[10:11], v[98:99], v[12:13]
    v_pk_fma_f32 v[98:99], v[10:11], v[8:9], v[98:99] neg_lo:[1,0,0] neg_hi:[1,0,0]
    v_pk_fma_f32 v[10:11], v[98:99], v[12:13], v[10:11]
    v_cvt_pk_bf16_f32 v43, v10, v11
    v_mul_u32_u24 v9, 928, v2
    v_lshl_add_u32 v9, v3, 4, v9
    s_add_u32 s12, s6, 0
    s_addc_u32 s13, s7, 0
    s_mov_b32 s14, 1835008
    s_mov_b32 s15, 0x00020000
    buffer_store_dwordx4 v[16:19], v1, s[12:15], 0 offen offset:0 sc1
    ds_write_b128 v9, v[16:19] offset:0
    buffer_store_dwordx4 v[20:23], v1, s[12:15], 0 offen offset:128 sc1
    ds_write_b128 v9, v[20:23] offset:128
    buffer_store_dwordx4 v[24:27], v1, s[12:15], 0 offen offset:256 sc1
    ds_write_b128 v9, v[24:27] offset:256
    buffer_store_dwordx4 v[28:31], v1, s[12:15], 0 offen offset:384 sc1
    ds_write_b128 v9, v[28:31] offset:384
    buffer_store_dwordx4 v[32:35], v1, s[12:15], 0 offen offset:512 sc1
    ds_write_b128 v9, v[32:35] offset:512
    buffer_store_dwordx4 v[36:39], v1, s[12:15], 0 offen offset:640 sc1
    ds_write_b128 v9, v[36:39] offset:640
    buffer_store_dwordx4 v[40:43], v1, s[12:15], 0 offen offset:768 sc1
    ds_write_b128 v9, v[40:43] offset:768
    s_waitcnt lgkmcnt(0)
    s_barrier
    v_and_b32 v10, 63, v0
    v_lshrrev_b32 v11, 6, v0
    v_lshrrev_b32 v15, 2, v11
    v_and_b32 v11, 3, v11
    v_lshrrev_b32 v12, 4, v10
    v_bfe_u32 v13, v10, 2, 2
    v_and_b32 v14, 3, v10
    v_lshl_add_u32 v13, v12, 3, v13
    v_lshl_add_u32 v13, v15, 5, v13

    v_mul_u32_u24 v13, 928, v13
    v_lshl_add_u32 v13, v14, 3, v13
    v_lshl_add_u32 v13, v11, 5, v13
    v_and_b32 v14, 15, v10
    v_lshl_add_u32 v14, v11, 4, v14
    v_lshlrev_b32 v14, 12, v14
    v_lshl_add_u32 v14, v12, 4, v14
    v_lshl_add_u32 v14, v15, 6, v14
    s_lshl_b32 s21, s3, 7
    v_add_u32 v14, s21, v14

    ds_read_b64_tr_b16 v[16:17], v13 offset:0
    ds_read_b64_tr_b16 v[18:19], v13 offset:3712
    ds_read_b64_tr_b16 v[20:21], v13 offset:128
    ds_read_b64_tr_b16 v[22:23], v13 offset:3840
    ds_read_b64_tr_b16 v[24:25], v13 offset:256
    ds_read_b64_tr_b16 v[26:27], v13 offset:3968
    ds_read_b64_tr_b16 v[28:29], v13 offset:384
    ds_read_b64_tr_b16 v[30:31], v13 offset:4096
    ds_read_b64_tr_b16 v[32:33], v13 offset:512
    ds_read_b64_tr_b16 v[34:35], v13 offset:4224
    ds_read_b64_tr_b16 v[36:37], v13 offset:640
    ds_read_b64_tr_b16 v[38:39], v13 offset:4352
    ds_read_b64_tr_b16 v[40:41], v13 offset:768
    ds_read_b64_tr_b16 v[42:43], v13 offset:4480
    s_waitcnt lgkmcnt(0)
    s_mov_b32 s22, 0
    buffer_store_dwordx4 v[16:19], v14, s[16:19], s22 offen sc1
    s_mov_b32 s22, 262144
    buffer_store_dwordx4 v[20:23], v14, s[16:19], s22 offen sc1
    s_mov_b32 s22, 524288
    buffer_store_dwordx4 v[24:27], v14, s[16:19], s22 offen sc1
    s_mov_b32 s22, 786432
    buffer_store_dwordx4 v[28:31], v14, s[16:19], s22 offen sc1
    s_mov_b32 s22, 1048576
    buffer_store_dwordx4 v[32:35], v14, s[16:19], s22 offen sc1
    s_mov_b32 s22, 1310720
    buffer_store_dwordx4 v[36:39], v14, s[16:19], s22 offen sc1
    s_mov_b32 s22, 1572864
    buffer_store_dwordx4 v[40:43], v14, s[16:19], s22 offen sc1
    s_endpgm
ka_kernel_pf:
    s_cmp_ge_u32 s2, 312
    s_cbranch_scc1 ka_kernel_exit
    s_sub_u32 s3, s2, 256
    s_cmp_ge_u32 s3, 28
    s_cselect_b32 s48, s82, s80
    s_cselect_b32 s49, s83, s81
    s_mov_b32 s50, 1605632
    s_mov_b32 s51, 0x00020000
    s_cselect_b32 s23, 28, 0
    s_sub_u32 s3, s3, s23
    s_mul_i32 s23, s3, 57344
    v_lshlrev_b32 v4, 4, v0
    buffer_load_dwordx4 v[8:11], v4, s[48:51], s23 offen
    s_add_u32 s23, s23, 8192
    buffer_load_dwordx4 v[8:11], v4, s[48:51], s23 offen
    s_add_u32 s23, s23, 8192
    buffer_load_dwordx4 v[8:11], v4, s[48:51], s23 offen
    s_add_u32 s23, s23, 8192
    buffer_load_dwordx4 v[8:11], v4, s[48:51], s23 offen
    s_add_u32 s23, s23, 8192
    buffer_load_dwordx4 v[8:11], v4, s[48:51], s23 offen
    s_add_u32 s23, s23, 8192
    buffer_load_dwordx4 v[8:11], v4, s[48:51], s23 offen
    s_add_u32 s23, s23, 8192
    buffer_load_dwordx4 v[8:11], v4, s[48:51], s23 offen
    s_waitcnt vmcnt(0)
ka_kernel_exit:
    s_endpgm
.globl kb_kernel
.p2align 8
.type kb_kernel,@function
kb_kernel:
    s_load_dwordx16 s[64:79], s[0:1], 0
    s_load_dwordx8 s[80:87], s[0:1], 64
    s_load_dwordx2 s[6:7], s[0:1], 96
    s_waitcnt lgkmcnt(0)
    s_mov_b32 s4, s64
    s_mov_b32 s5, s65
    s_cmp_ge_u32 s2, 480
    s_cbranch_scc1 kb_kernel_exit
    s_cmp_ge_u32 s2, 256
    s_cbranch_scc1 kb_kernel_conv
    v_and_b32 v1, 63, v0
    v_lshrrev_b32 v2, 6, v0
    s_nop 0
    v_readfirstlane_b32 s22, v2
    s_nop 3

    s_add_u32 s52, s6, 18874368
    s_addc_u32 s53, s7, 0
    s_mov_b32 s54, 8192
    s_mov_b32 s55, 0x00020000
    s_getreg_b32 s27, hwreg(HW_REG_XCC_ID)
    s_and_b32 s27, s27, 7
    s_cmp_lg_u32 s22, 0
    s_cbranch_scc1 L_cl_skip_7
    s_mov_b64 s[30:31], exec
    s_mov_b64 exec, 3
    s_lshl_b32 s26, s27, 8
    v_lshlrev_b32 v4, 12, v0
    v_add_u32 v4, s26, v4
    v_mov_b32 v5, 1
    buffer_atomic_add v5, v4, s[52:55], 0 offen sc0
    s_waitcnt vmcnt(0)
    v_readlane_b32 s88, v5, 0
    v_readlane_b32 s89, v5, 1
    s_mov_b32 s29, s27
    s_mov_b32 s27, s29
    s_nop 3
    s_cmp_lt_u32 s88, 28
    s_cbranch_scc1 L_cl_done_9
    s_mov_b64 exec, 0xff
    v_lshlrev_b32 v4, 8, v0
    v_add_u32 v4, 0, v4
    buffer_load_dword v6, v4, s[52:55], 0 offen sc1
    s_waitcnt vmcnt(0)
    v_cmp_gt_u32 vcc, 28, v6
    s_mov_b64 exec, 1
    s_nop 3
    s_mov_b32 s28, vcc_lo
L_cl_loop_8:
    s_cmp_eq_u32 s28, 0
    s_cbranch_scc1 L_cl_no_10
    s_ff1_i32_b32 s27, s28
    s_bitset0_b32 s28, s27
    s_lshl_b32 s26, s27, 8
    s_add_u32 s26, s26, 0
    v_mov_b32 v4, s26
    v_mov_b32 v5, 1
    buffer_atomic_add v5, v4, s[52:55], 0 offen sc0
    s_waitcnt vmcnt(0)
    v_readfirstlane_b32 s88, v5
    s_nop 3
    s_cmp_lt_u32 s88, 28
    s_cbranch_scc1 L_cl_done_9
    s_branch L_cl_loop_8
L_cl_no_10:
    s_mov_b32 s88, 0xff
L_cl_done_9:
    s_lshl_b32 s28, s27, 8
    s_or_b32 s88, s88, s28
    s_mov_b32 s27, s29
    s_nop 3
    s_cmp_lt_u32 s89, 28
    s_cbranch_scc1 L_cl_done_12
    s_mov_b64 exec, 0xff
    v_lshlrev_b32 v4, 8, v0
    v_add_u32 v4, 4096, v4
    buffer_load_dword v6, v4, s[52:55], 0 offen sc1
    s_waitcnt vmcnt(0)
    v_cmp_gt_u32 vcc, 28, v6
    s_mov_b64 exec, 1
    s_nop 3
    s_mov_b32 s28, vcc_lo
L_cl_loop_11:
    s_cmp_eq_u32 s28, 0
    s_cbranch_scc1 L_cl_no_13
    s_ff1_i32_b32 s27, s28
    s_bitset0_b32 s28, s27
    s_lshl_b32 s26, s27, 8
    s_add_u32 s26, s26, 4096
    v_mov_b32 v4, s26
    v_mov_b32 v5, 1
    buffer_atomic_add v5, v4, s[52:55], 0 offen sc0
    s_waitcnt vmcnt(0)
    v_readfirstlane_b32 s89, v5
    s_nop 3
    s_cmp_lt_u32 s89, 28
    s_cbranch_scc1 L_cl_done_12
    s_branch L_cl_loop_11
L_cl_no_13:
    s_mov_b32 s89, 0xff
L_cl_done_12:
    s_lshl_b32 s28, s27, 8
    s_or_b32 s89, s89, s28
    s_mov_b64 exec, 1
    v_mov_b32 v4, 0
    v_mov_b32 v6, s88
    v_mov_b32 v7, s89
    ds_write_b64 v4, v[6:7]
    s_waitcnt lgkmcnt(0)
    s_mov_b64 exec, s[30:31]
L_cl_skip_7:
    s_barrier
    v_mov_b32 v4, 0
    ds_read_b64 v[6:7], v4
    s_waitcnt lgkmcnt(0)
    v_readfirstlane_b32 s88, v6
    v_readfirstlane_b32 s89, v7
    s_barrier
    s_setprio 2
    s_add_u32 s8, s6, 0
    s_addc_u32 s9, s7, 0
    s_mov_b32 s10, 1835008
    s_mov_b32 s11, 0x00020000
    s_add_u32 s16, s6, 6291456
    s_addc_u32 s17, s7, 0
    s_mov_b32 s18, 7340032
    s_mov_b32 s19, 0x00020000
    s_mov_b32 s12, s80
    s_mov_b32 s13, s81
    s_mov_b32 s14, 1605632
    s_mov_b32 s15, 0x00020000
    s_and_b32 s26, s88, 0xff
    s_lshr_b32 s27, s88, 8
    s_cmp_eq_u32 s26, 0xff
    s_cbranch_scc1 kb_kernel_exit
    s_cmp_ge_u32 s26, 14
    s_cselect_b32 s20, 1, 0
    s_mul_i32 s21, s20, 14
    s_sub_u32 s21, s26, s21
    s_lshl_b32 s27, s27, 1
    s_add_u32 s20, s20, s27
    s_mov_b32 s29, s26
    v_lshrrev_b32 v3, 3, v1
    v_lshl_add_u32 v3, v2, 4, v3
    s_lshl_b32 s23, s20, 7
    v_add_u32 v3, s23, v3
    v_mul_u32_u24 v3, 896, v3
    v_and_b32 v4, 7, v1
    v_lshrrev_b32 v5, 4, v1
    v_xor_b32 v4, v4, v5
    v_lshl_add_u32 v3, v4, 4, v3
    v_xor_b32 v4, 64, v3
    v_bfe_u32 v6, v1, 4, 2
    v_lshrrev_b32 v5, 4, v1
    v_lshl_add_u32 v5, v2, 3, v5
    v_mul_u32_u24 v5, 3584, v5
    v_bfe_u32 v7, v1, 2, 2
    v_xor_b32 v6, v6, v7
    v_and_b32 v7, 3, v1
    v_lshl_add_u32 v6, v6, 2, v7
    v_lshl_add_u32 v5, v6, 4, v5
    s_lshl_b32 s23, s21, 8
    v_add_u32 v5, s23, v5
    s_lshl_b32 s24, s22, 11

    s_mul_hi_u32 s30, s29, 0x24924925
    s_mul_i32 s30, s30, 7
    s_sub_u32 s31, s29, s30
    s_lshl_b32 s32, s31, 7
    s_add_u32 s31, s31, 1
    s_cmp_eq_u32 s31, 7
    s_cselect_b32 s31, 0, s31
    s_lshl_b32 s33, s31, 7
    s_add_u32 s31, s31, 1
    s_cmp_eq_u32 s31, 7
    s_cselect_b32 s31, 0, s31
    s_lshl_b32 s34, s31, 7
    s_add_u32 s31, s31, 1
    s_cmp_eq_u32 s31, 7
    s_cselect_b32 s31, 0, s31
    s_lshl_b32 s35, s31, 7
    s_add_u32 s31, s31, 1
    s_cmp_eq_u32 s31, 7
    s_cselect_b32 s31, 0, s31
    s_lshl_b32 s36, s31, 7
    s_add_u32 s31, s31, 1
    s_cmp_eq_u32 s31, 7
    s_cselect_b32 s31, 0, s31
    s_lshl_b32 s37, s31, 7
    s_add_u32 s31, s31, 1
    s_cmp_eq_u32 s31, 7
    s_cselect_b32 s31, 0, s31
    s_lshl_b32 s38, s31, 7
    s_add_u32 s31, s31, 1
    s_cmp_eq_u32 s31, 7
    s_cselect_b32 s31, 0, s31
    s_mul_i32 s30, s32, 1792
    s_add_u32 m0, s24, 0
    s_add_u32 s25, s30, 0
    buffer_load_dwordx4 v5, s[12:15], s25 offen lds
    s_add_u32 m0, s24, 1024
    s_add_u32 s25, s30, 14336
    buffer_load_dwordx4 v5, s[12:15], s25 offen lds
    s_add_u32 m0, s24, 8192
    s_add_u32 s25, s32, 0
    buffer_load_dwordx4 v3, s[8:11], s25 offen lds
    s_add_u32 m0, s24, 9216
    s_add_u32 s25, s32, 7168
    buffer_load_dwordx4 v4, s[8:11], s25 offen lds
    s_add_u32 m0, s24, 16384
    s_add_u32 s25, s32, 57344
    buffer_load_dwordx4 v3, s[8:11], s25 offen lds
    s_add_u32 m0, s24, 17408
    s_add_u32 s25, s32, 64512
    buffer_load_dwordx4 v4, s[8:11], s25 offen lds
    s_mul_i32 s30, s32, 1792
    s_add_u32 m0, s24, 24576
    s_add_u32 s25, s30, 114688
    buffer_load_dwordx4 v5, s[12:15], s25 offen lds
    s_add_u32 m0, s24, 25600
    s_add_u32 s25, s30, 129024
    buffer_load_dwordx4 v5, s[12:15], s25 offen lds
    s_mul_i32 s30, s33, 1792
    s_add_u32 m0, s24, 32768
    s_add_u32 s25, s30, 0
    buffer_load_dwordx4 v5, s[12:15], s25 offen lds
    s_add_u32 m0, s24, 33792
    s_add_u32 s25, s30, 14336
    buffer_load_dwordx4 v5, s[12:15], s25 offen lds
    s_add_u32 m0, s24, 40960
    s_add_u32 s25, s33, 0
    buffer_load_dwordx4 v3, s[8:11], s25 offen lds
    s_add_u32 m0, s24, 41984
    s_add_u32 s25, s33, 7168
    buffer_load_dwordx4 v4, s[8:11], s25 offen lds
    s_add_u32 m0, s24, 49152
    s_add_u32 s25, s33, 57344
    buffer_load_dwordx4 v3, s[8:11], s25 offen lds
    s_add_u32 m0, s24, 50176
    s_add_u32 s25, s33, 64512
    buffer_load_dwordx4 v4, s[8:11], s25 offen lds
    s_mul_i32 s30, s33, 1792
    s_add_u32 m0, s24, 57344
    s_add_u32 s25, s30, 114688
    buffer_load_dwordx4 v5, s[12:15], s25 offen lds
    s_add_u32 m0, s24, 58368
    s_add_u32 s25, s30, 129024
    buffer_load_dwordx4 v5, s[12:15], s25 offen lds
    s_mul_i32 s30, s34, 1792
    s_add_u32 m0, s24, 65536
    s_add_u32 s25, s30, 0
    buffer_load_dwordx4 v5, s[12:15], s25 offen lds
    s_add_u32 m0, s24, 66560
    s_add_u32 s25, s30, 14336
    buffer_load_dwordx4 v5, s[12:15], s25 offen lds
    s_add_u32 m0, s24, 73728
    s_add_u32 s25, s34, 0
    buffer_load_dwordx4 v3, s[8:11], s25 offen lds
    s_add_u32 m0, s24, 74752
    s_add_u32 s25, s34, 7168
    buffer_load_dwordx4 v4, s[8:11], s25 offen lds
    v_and_b32 v8, 31, v1
    v_lshrrev_b32 v9, 5, v1
    v_lshrrev_b32 v10, 1, v2
    v_and_b32 v11, 1, v2
    s_lshr_b32 s28, s22, 1
    v_lshlrev_b32 v12, 7, v8
    v_bfe_u32 v13, v8, 1, 3
    v_xor_b32 v13, v13, v9
    v_lshl_add_u32 v12, v13, 4, v12
    v_bfe_u32 v14, v1, 2, 2
    v_lshl_add_u32 v15, v9, 3, v14
    v_lshlrev_b32 v15, 8, v15
    v_lshlrev_b32 v16, 1, v11
    v_xor_b32 v16, v16, v14
    v_lshl_add_u32 v15, v16, 6, v15
    v_bfe_u32 v16, v1, 4, 1
    v_lshl_add_u32 v15, v16, 5, v15
    v_and_b32 v16, 3, v1
    v_lshl_add_u32 v15, v16, 3, v15

    v_mov_b32 v64, 0
    v_mov_b32 v65, 0
    v_mov_b32 v66, 0
    v_mov_b32 v67, 0
    v_mov_b32 v68, 0
    v_mov_b32 v69, 0
    v_mov_b32 v70, 0
    v_mov_b32 v71, 0
    v_mov_b32 v72, 0
    v_mov_b32 v73, 0
    v_mov_b32 v74, 0
    v_mov_b32 v75, 0
    v_mov_b32 v76, 0
    v_mov_b32 v77, 0
    v_mov_b32 v78, 0
    v_mov_b32 v79, 0
    v_mov_b32 v80, 0
    v_mov_b32 v81, 0
    v_mov_b32 v82, 0
    v_mov_b32 v83, 0
    v_mov_b32 v84, 0
    v_mov_b32 v85, 0
    v_mov_b32 v86, 0
    v_mov_b32 v87, 0
    v_mov_b32 v88, 0
    v_mov_b32 v89, 0
    v_mov_b32 v90, 0
    v_mov_b32 v91, 0
    v_mov_b32 v92, 0
    v_mov_b32 v93, 0
    v_mov_b32 v94, 0
    v_mov_b32 v95, 0
    v_mov_b32 v96, 0
    v_mov_b32 v97, 0
    v_mov_b32 v98, 0
    v_mov_b32 v99, 0
    v_mov_b32 v100, 0
    v_mov_b32 v101, 0
    v_mov_b32 v102, 0
    v_mov_b32 v103, 0
    v_mov_b32 v104, 0
    v_mov_b32 v105, 0
    v_mov_b32 v106, 0
    v_mov_b32 v107, 0
    v_mov_b32 v108, 0
    v_mov_b32 v109, 0
    v_mov_b32 v110, 0
    v_mov_b32 v111, 0
    v_mov_b32 v112, 0
    v_mov_b32 v113, 0
    v_mov_b32 v114, 0
    v_mov_b32 v115, 0
    v_mov_b32 v116, 0
    v_mov_b32 v117, 0
    v_mov_b32 v118, 0
    v_mov_b32 v119, 0
    v_mov_b32 v120, 0
    v_mov_b32 v121, 0
    v_mov_b32 v122, 0
    v_mov_b32 v123, 0
    v_mov_b32 v124, 0
    v_mov_b32 v125, 0
    v_mov_b32 v126, 0
    v_mov_b32 v127, 0
    s_waitcnt vmcnt(14)
    s_barrier
    s_mov_b32 s26, 8192
    s_mov_b32 s27, 16384
    s_cmp_eq_u32 s28, 0
    s_cselect_b32 s26, s26, s27
    v_xor_b32 v17, 0, v12
    v_add_u32 v17, s26, v17
    v_xor_b32 v18, 32, v17
    v_add_u32 v19, 0, v15
    v_xor_b32 v20, 64, v19
    ds_read_b128 v[32:35], v17 offset:0
    ds_read_b128 v[36:39], v17 offset:4096
    ds_read_b64_tr_b16 v[48:49], v19 offset:0
    ds_read_b64_tr_b16 v[50:51], v19 offset:1024
    ds_read_b64_tr_b16 v[52:53], v20 offset:0
    ds_read_b64_tr_b16 v[54:55], v20 offset:1024
    ds_read_b128 v[40:43], v18 offset:0
    ds_read_b128 v[44:47], v18 offset:4096
    ds_read_b64_tr_b16 v[56:57], v19 offset:4096
    ds_read_b64_tr_b16 v[58:59], v19 offset:5120
    ds_read_b64_tr_b16 v[60:61], v20 offset:4096
    ds_read_b64_tr_b16 v[62:63], v20 offset:5120
    s_waitcnt vmcnt(12)
    s_waitcnt lgkmcnt(0)
    s_barrier
    v_mfma_f32_32x32x16_bf16 v[64:79], v[48:51], v[32:35], v[64:79]
    s_add_u32 m0, s24, 0
    s_add_u32 s25, s34, 57344
    buffer_load_dwordx4 v3, s[8:11], s25 offen lds
    s_add_u32 m0, s24, 1024
    v_mfma_f32_32x32x16_bf16 v[80:95], v[52:55], v[32:35], v[80:95]
    s_add_u32 s25, s34, 64512
    buffer_load_dwordx4 v4, s[8:11], s25 offen lds
    s_mov_b32 s26, 8192
    s_mov_b32 s27, 16384
    v_mfma_f32_32x32x16_bf16 v[96:111], v[48:51], v[36:39], v[96:111]
    s_cmp_eq_u32 s28, 0
    s_cselect_b32 s26, s26, s27
    v_xor_b32 v17, 64, v12
    v_add_u32 v17, s26, v17
    v_mfma_f32_32x32x16_bf16 v[112:127], v[52:55], v[36:39], v[112:127]
    v_xor_b32 v18, 32, v17
    v_add_u32 v19, 24576, v15
    v_xor_b32 v20, 64, v19
    ds_read_b128 v[128:131], v17 offset:0
    v_mfma_f32_32x32x16_bf16 v[64:79], v[56:59], v[40:43], v[64:79]
    ds_read_b128 v[132:135], v17 offset:4096
    ds_read_b64_tr_b16 v[144:145], v19 offset:0
    ds_read_b64_tr_b16 v[146:147], v19 offset:1024
    ds_read_b64_tr_b16 v[148:149], v20 offset:0
    v_mfma_f32_32x32x16_bf16 v[80:95], v[60:63], v[40:43], v[80:95]
    ds_read_b64_tr_b16 v[150:151], v20 offset:1024
    ds_read_b128 v[136:139], v18 offset:0
    ds_read_b128 v[140:143], v18 offset:4096
    ds_read_b64_tr_b16 v[152:153], v19 offset:4096
    v_mfma_f32_32x32x16_bf16 v[96:111], v[56:59], v[44:47], v[96:111]
    ds_read_b64_tr_b16 v[154:155], v19 offset:5120
    ds_read_b64_tr_b16 v[156:157], v20 offset:4096
    ds_read_b64_tr_b16 v[158:159], v20 offset:5120
    v_mfma_f32_32x32x16_bf16 v[112:127], v[60:63], v[44:47], v[112:127]
    s_waitcnt vmcnt(8)
    s_waitcnt lgkmcnt(0)
    s_barrier
    v_mfma_f32_32x32x16_bf16 v[64:79], v[144:147], v[128:131], v[64:79]
    s_mul_i32 s30, s34, 1792
    s_add_u32 m0, s24, 8192
    s_add_u32 s25, s30, 114688
    buffer_load_dwordx4 v5, s[12:15], s25 offen lds
    s_add_u32 m0, s24, 9216
    s_add_u32 s25, s30, 129024
    v_mfma_f32_32x32x16_bf16 v[80:95], v[148:151], v[128:131], v[80:95]
    buffer_load_dwordx4 v5, s[12:15], s25 offen lds
    s_mul_i32 s30, s35, 1792
    s_add_u32 m0, s24, 16384
    s_add_u32 s25, s30, 0
    buffer_load_dwordx4 v5, s[12:15], s25 offen lds
    s_add_u32 m0, s24, 17408
    v_mfma_f32_32x32x16_bf16 v[96:111], v[144:147], v[132:135], v[96:111]
    s_add_u32 s25, s30, 14336
    buffer_load_dwordx4 v5, s[12:15], s25 offen lds
    s_add_u32 m0, s24, 24576
    s_add_u32 s25, s35, 0
    buffer_load_dwordx4 v3, s[8:11], s25 offen lds
    s_add_u32 m0, s24, 25600
    v_mfma_f32_32x32x16_bf16 v[112:127], v[148:151], v[132:135], v[112:127]
    s_add_u32 s25, s35, 7168
    buffer_load_dwordx4 v4, s[8:11], s25 offen lds
    s_mov_b32 s26, 40960
    s_mov_b32 s27, 49152
    s_cmp_eq_u32 s28, 0
    s_cselect_b32 s26, s26, s27
    v_mfma_f32_32x32x16_bf16 v[64:79], v[152:155], v[136:139], v[64:79]
    v_xor_b32 v17, 0, v12
    v_add_u32 v17, s26, v17
    v_xor_b32 v18, 32, v17
    v_add_u32 v19, 32768, v15
    v_xor_b32 v20, 64, v19
    ds_read_b128 v[32:35], v17 offset:0
    v_mfma_f32_32x32x16_bf16 v[80:95], v[156:159], v[136:139], v[80:95]
    ds_read_b128 v[36:39], v17 offset:4096
    ds_read_b64_tr_b16 v[48:49], v19 offset:0
    ds_read_b64_tr_b16 v[50:51], v19 offset:1024
    ds_read_b64_tr_b16 v[52:53], v20 offset:0
    ds_read_b64_tr_b16 v[54:55], v20 offset:1024
    ds_read_b128 v[40:43], v18 offset:0
    v_mfma_f32_32x32x16_bf16 v[96:111], v[152:155], v[140:143], v[96:111]
    ds_read_b128 v[44:47], v18 offset:4096
    ds_read_b64_tr_b16 v[56:57], v19 offset:4096
    ds_read_b64_tr_b16 v[58:59], v19 offset:5120
    ds_read_b64_tr_b16 v[60:61], v20 offset:4096
    ds_read_b64_tr_b16 v[62:63], v20 offset:5120
    v_mfma_f32_32x32x16_bf16 v[112:127], v[156:159], v[140:143], v[112:127]
    s_waitcnt vmcnt(12)
    s_waitcnt lgkmcnt(0)
    s_barrier
    v_mfma_f32_32x32x16_bf16 v[64:79], v[48:51], v[32:35], v[64:79]
    s_add_u32 m0, s24, 32768
    s_add_u32 s25, s35, 57344
    buffer_load_dwordx4 v3, s[8:11], s25 offen lds
    s_add_u32 m0, s24, 33792
    v_mfma_f32_32x32x16_bf16 v[80:95], v[52:55], v[32:35], v[80:95]
    s_add_u32 s25, s35, 64512
    buffer_load_dwordx4 v4, s[8:11], s25 offen lds
    s_mov_b32 s26, 40960
    s_mov_b32 s27, 49152
    v_mfma_f32_32x32x16_bf16 v[96:111], v[48:51], v[36:39], v[96:111]
    s_cmp_eq_u32 s28, 0
    s_cselect_b32 s26, s26, s27
    v_xor_b32 v17, 64, v12
    v_add_u32 v17, s26, v17
    v_mfma_f32_32x32x16_bf16 v[112:127], v[52:55], v[36:39], v[112:127]
    v_xor_b32 v18, 32, v17
    v_add_u32 v19, 57344, v15
    v_xor_b32 v20, 64, v19
    ds_read_b128 v[128:131], v17 offset:0
    v_mfma_f32_32x32x16_bf16 v[64:79], v[56:59], v[40:43], v[64:79]
    ds_read_b128 v[132:135], v17 offset:4096
    ds_read_b64_tr_b16 v[144:145], v19 offset:0
    ds_read_b64_tr_b16 v[146:147], v19 offset:1024
    ds_read_b64_tr_b16 v[148:149], v20 offset:0
    v_mfma_f32_32x32x16_bf16 v[80:95], v[60:63], v[40:43], v[80:95]
    ds_read_b64_tr_b16 v[150:151], v20 offset:1024
    ds_read_b128 v[136:139], v18 offset:0
    ds_read_b128 v[140:143], v18 offset:4096
    ds_read_b64_tr_b16 v[152:153], v19 offset:4096
    v_mfma_f32_32x32x16_bf16 v[96:111], v[56:59], v[44:47], v[96:111]
    ds_read_b64_tr_b16 v[154:155], v19 offset:5120
    ds_read_b64_tr_b16 v[156:157], v20 offset:4096
    ds_read_b64_tr_b16 v[158:159], v20 offset:5120
    v_mfma_f32_32x32x16_bf16 v[112:127], v[60:63], v[44:47], v[112:127]
    s_waitcnt vmcnt(8)
    s_waitcnt lgkmcnt(0)
    s_barrier
    v_mfma_f32_32x32x16_bf16 v[64:79], v[144:147], v[128:131], v[64:79]
    s_mul_i32 s30, s35, 1792
    s_add_u32 m0, s24, 40960
    s_add_u32 s25, s30, 114688
    buffer_load_dwordx4 v5, s[12:15], s25 offen lds
    s_add_u32 m0, s24, 41984
    s_add_u32 s25, s30, 129024
    v_mfma_f32_32x32x16_bf16 v[80:95], v[148:151], v[128:131], v[80:95]
    buffer_load_dwordx4 v5, s[12:15], s25 offen lds
    s_mul_i32 s30, s36, 1792
    s_add_u32 m0, s24, 49152
    s_add_u32 s25, s30, 0
    buffer_load_dwordx4 v5, s[12:15], s25 offen lds
    s_add_u32 m0, s24, 50176
    v_mfma_f32_32x32x16_bf16 v[96:111], v[144:147], v[132:135], v[96:111]
    s_add_u32 s25, s30, 14336
    buffer_load_dwordx4 v5, s[12:15], s25 offen lds
    s_add_u32 m0, s24, 57344
    s_add_u32 s25, s36, 0
    buffer_load_dwordx4 v3, s[8:11], s25 offen lds
    s_add_u32 m0, s24, 58368
    v_mfma_f32_32x32x16_bf16 v[112:127], v[148:151], v[132:135], v[112:127]
    s_add_u32 s25, s36, 7168
    buffer_load_dwordx4 v4, s[8:11], s25 offen lds
    s_mov_b32 s26, 73728
    s_mov_b32 s27, 0
    s_cmp_eq_u32 s28, 0
    s_cselect_b32 s26, s26, s27
    v_mfma_f32_32x32x16_bf16 v[64:79], v[152:155], v[136:139], v[64:79]
    v_xor_b32 v17, 0, v12
    v_add_u32 v17, s26, v17
    v_xor_b32 v18, 32, v17
    v_add_u32 v19, 65536, v15
    v_xor_b32 v20, 64, v19
    ds_read_b128 v[32:35], v17 offset:0
    v_mfma_f32_32x32x16_bf16 v[80:95], v[156:159], v[136:139], v[80:95]
    ds_read_b128 v[36:39], v17 offset:4096
    ds_read_b64_tr_b16 v[48:49], v19 offset:0
    ds_read_b64_tr_b16 v[50:51], v19 offset:1024
    ds_read_b64_tr_b16 v[52:53], v20 offset:0
    ds_read_b64_tr_b16 v[54:55], v20 offset:1024
    ds_read_b128 v[40:43], v18 offset:0
    v_mfma_f32_32x32x16_bf16 v[96:111], v[152:155], v[140:143], v[96:111]
    ds_read_b128 v[44:47], v18 offset:4096
    ds_read_b64_tr_b16 v[56:57], v19 offset:4096
    ds_read_b64_tr_b16 v[58:59], v19 offset:5120
    ds_read_b64_tr_b16 v[60:61], v20 offset:4096
    ds_read_b64_tr_b16 v[62:63], v20 offset:5120
    v_mfma_f32_32x32x16_bf16 v[112:127], v[156:159], v[140:143], v[112:127]
    s_waitcnt vmcnt(12)
    s_waitcnt lgkmcnt(0)
    s_barrier
    v_mfma_f32_32x32x16_bf16 v[64:79], v[48:51], v[32:35], v[64:79]
    s_add_u32 m0, s24, 65536
    s_add_u32 s25, s36, 57344
    buffer_load_dwordx4 v3, s[8:11], s25 offen lds
    s_add_u32 m0, s24, 66560
    v_mfma_f32_32x32x16_bf16 v[80:95], v[52:55], v[32:35], v[80:95]
    s_add_u32 s25, s36, 64512
    buffer_load_dwordx4 v4, s[8:11], s25 offen lds
    s_mov_b32 s26, 73728
    s_mov_b32 s27, 0
    v_mfma_f32_32x32x16_bf16 v[96:111], v[48:51], v[36:39], v[96:111]
    s_cmp_eq_u32 s28, 0
    s_cselect_b32 s26, s26, s27
    v_xor_b32 v17, 64, v12
    v_add_u32 v17, s26, v17
    v_mfma_f32_32x32x16_bf16 v[112:127], v[52:55], v[36:39], v[112:127]
    v_xor_b32 v18, 32, v17
    v_add_u32 v19, 8192, v15
    v_xor_b32 v20, 64, v19
    ds_read_b128 v[128:131], v17 offset:0
    v_mfma_f32_32x32x16_bf16 v[64:79], v[56:59], v[40:43], v[64:79]
    ds_read_b128 v[132:135], v17 offset:4096
    ds_read_b64_tr_b16 v[144:145], v19 offset:0
    ds_read_b64_tr_b16 v[146:147], v19 offset:1024
    ds_read_b64_tr_b16 v[148:149], v20 offset:0
    v_mfma_f32_32x32x16_bf16 v[80:95], v[60:63], v[40:43], v[80:95]
    ds_read_b64_tr_b16 v[150:151], v20 offset:1024
    ds_read_b128 v[136:139], v18 offset:0
    ds_read_b128 v[140:143], v18 offset:4096
    ds_read_b64_tr_b16 v[152:153], v19 offset:4096
    v_mfma_f32_32x32x16_bf16 v[96:111], v[56:59], v[44:47], v[96:111]
    ds_read_b64_tr_b16 v[154:155], v19 offset:5120
    ds_read_b64_tr_b16 v[156:157], v20 offset:4096
    ds_read_b64_tr_b16 v[158:159], v20 offset:5120
    v_mfma_f32_32x32x16_bf16 v[112:127], v[60:63], v[44:47], v[112:127]
    s_waitcnt vmcnt(8)
    s_waitcnt lgkmcnt(0)
    s_barrier
    v_mfma_f32_32x32x16_bf16 v[64:79], v[144:147], v[128:131], v[64:79]
    s_mul_i32 s30, s36, 1792
    s_add_u32 m0, s24, 73728
    s_add_u32 s25, s30, 114688
    buffer_load_dwordx4 v5, s[12:15], s25 offen lds
    s_add_u32 m0, s24, 74752
    s_add_u32 s25, s30, 129024
    v_mfma_f32_32x32x16_bf16 v[80:95], v[148:151], v[128:131], v[80:95]
    buffer_load_dwordx4 v5, s[12:15], s25 offen lds
    s_mul_i32 s30, s37, 1792
    s_add_u32 m0, s24, 0
    s_add_u32 s25, s30, 0
    buffer_load_dwordx4 v5, s[12:15], s25 offen lds
    s_add_u32 m0, s24, 1024
    v_mfma_f32_32x32x16_bf16 v[96:111], v[144:147], v[132:135], v[96:111]
    s_add_u32 s25, s30, 14336
    buffer_load_dwordx4 v5, s[12:15], s25 offen lds
    s_add_u32 m0, s24, 8192
    s_add_u32 s25, s37, 0
    buffer_load_dwordx4 v3, s[8:11], s25 offen lds
    s_add_u32 m0, s24, 9216
    v_mfma_f32_32x32x16_bf16 v[112:127], v[148:151], v[132:135], v[112:127]
    s_add_u32 s25, s37, 7168
    buffer_load_dwordx4 v4, s[8:11], s25 offen lds
    s_mov_b32 s26, 24576
    s_mov_b32 s27, 32768
    s_cmp_eq_u32 s28, 0
    s_cselect_b32 s26, s26, s27
    v_mfma_f32_32x32x16_bf16 v[64:79], v[152:155], v[136:139], v[64:79]
    v_xor_b32 v17, 0, v12
    v_add_u32 v17, s26, v17
    v_xor_b32 v18, 32, v17
    v_add_u32 v19, 16384, v15
    v_xor_b32 v20, 64, v19
    ds_read_b128 v[32:35], v17 offset:0
    v_mfma_f32_32x32x16_bf16 v[80:95], v[156:159], v[136:139], v[80:95]
    ds_read_b128 v[36:39], v17 offset:4096
    ds_read_b64_tr_b16 v[48:49], v19 offset:0
    ds_read_b64_tr_b16 v[50:51], v19 offset:1024
    ds_read_b64_tr_b16 v[52:53], v20 offset:0
    ds_read_b64_tr_b16 v[54:55], v20 offset:1024
    ds_read_b128 v[40:43], v18 offset:0
    v_mfma_f32_32x32x16_bf16 v[96:111], v[152:155], v[140:143], v[96:111]
    ds_read_b128 v[44:47], v18 offset:4096
    ds_read_b64_tr_b16 v[56:57], v19 offset:4096
    ds_read_b64_tr_b16 v[58:59], v19 offset:5120
    ds_read_b64_tr_b16 v[60:61], v20 offset:4096
    ds_read_b64_tr_b16 v[62:63], v20 offset:5120
    v_mfma_f32_32x32x16_bf16 v[112:127], v[156:159], v[140:143], v[112:127]
    s_waitcnt vmcnt(12)
    s_waitcnt lgkmcnt(0)
    s_barrier
    v_mfma_f32_32x32x16_bf16 v[64:79], v[48:51], v[32:35], v[64:79]
    s_add_u32 m0, s24, 16384
    s_add_u32 s25, s37, 57344
    buffer_load_dwordx4 v3, s[8:11], s25 offen lds
    s_add_u32 m0, s24, 17408
    v_mfma_f32_32x32x16_bf16 v[80:95], v[52:55], v[32:35], v[80:95]
    s_add_u32 s25, s37, 64512
    buffer_load_dwordx4 v4, s[8:11], s25 offen lds
    s_mov_b32 s26, 24576
    s_mov_b32 s27, 32768
    v_mfma_f32_32x32x16_bf16 v[96:111], v[48:51], v[36:39], v[96:111]
    s_cmp_eq_u32 s28, 0
    s_cselect_b32 s26, s26, s27
    v_xor_b32 v17, 64, v12
    v_add_u32 v17, s26, v17
    v_mfma_f32_32x32x16_bf16 v[112:127], v[52:55], v[36:39], v[112:127]
    v_xor_b32 v18, 32, v17
    v_add_u32 v19, 40960, v15
    v_xor_b32 v20, 64, v19
    ds_read_b128 v[128:131], v17 offset:0
    v_mfma_f32_32x32x16_bf16 v[64:79], v[56:59], v[40:43], v[64:79]
    ds_read_b128 v[132:135], v17 offset:4096
    ds_read_b64_tr_b16 v[144:145], v19 offset:0
    ds_read_b64_tr_b16 v[146:147], v19 offset:1024
    ds_read_b64_tr_b16 v[148:149], v20 offset:0
    v_mfma_f32_32x32x16_bf16 v[80:95], v[60:63], v[40:43], v[80:95]
    ds_read_b64_tr_b16 v[150:151], v20 offset:1024
    ds_read_b128 v[136:139], v18 offset:0
    ds_read_b128 v[140:143], v18 offset:4096
    ds_read_b64_tr_b16 v[152:153], v19 offset:4096
    v_mfma_f32_32x32x16_bf16 v[96:111], v[56:59], v[44:47], v[96:111]
    ds_read_b64_tr_b16 v[154:155], v19 offset:5120
    ds_read_b64_tr_b16 v[156:157], v20 offset:4096
    ds_read_b64_tr_b16 v[158:159], v20 offset:5120
    v_mfma_f32_32x32x16_bf16 v[112:127], v[60:63], v[44:47], v[112:127]
    s_waitcnt vmcnt(8)
    s_waitcnt lgkmcnt(0)
    s_barrier
    v_mfma_f32_32x32x16_bf16 v[64:79], v[144:147], v[128:131], v[64:79]
    s_mul_i32 s30, s37, 1792
    s_add_u32 m0, s24, 24576
    s_add_u32 s25, s30, 114688
    buffer_load_dwordx4 v5, s[12:15], s25 offen lds
    s_add_u32 m0, s24, 25600
    s_add_u32 s25, s30, 129024
    v_mfma_f32_32x32x16_bf16 v[80:95], v[148:151], v[128:131], v[80:95]
    buffer_load_dwordx4 v5, s[12:15], s25 offen lds
    s_mul_i32 s30, s38, 1792
    s_add_u32 m0, s24, 32768
    s_add_u32 s25, s30, 0
    buffer_load_dwordx4 v5, s[12:15], s25 offen lds
    s_add_u32 m0, s24, 33792
    v_mfma_f32_32x32x16_bf16 v[96:111], v[144:147], v[132:135], v[96:111]
    s_add_u32 s25, s30, 14336
    buffer_load_dwordx4 v5, s[12:15], s25 offen lds
    s_add_u32 m0, s24, 40960
    s_add_u32 s25, s38, 0
    buffer_load_dwordx4 v3, s[8:11], s25 offen lds
    s_add_u32 m0, s24, 41984
    v_mfma_f32_32x32x16_bf16 v[112:127], v[148:151], v[132:135], v[112:127]
    s_add_u32 s25, s38, 7168
    buffer_load_dwordx4 v4, s[8:11], s25 offen lds
    s_mov_b32 s26, 57344
    s_mov_b32 s27, 65536
    s_cmp_eq_u32 s28, 0
    s_cselect_b32 s26, s26, s27
    v_mfma_f32_32x32x16_bf16 v[64:79], v[152:155], v[136:139], v[64:79]
    v_xor_b32 v17, 0, v12
    v_add_u32 v17, s26, v17
    v_xor_b32 v18, 32, v17
    v_add_u32 v19, 49152, v15
    v_xor_b32 v20, 64, v19
    ds_read_b128 v[32:35], v17 offset:0
    v_mfma_f32_32x32x16_bf16 v[80:95], v[156:159], v[136:139], v[80:95]
    ds_read_b128 v[36:39], v17 offset:4096
    ds_read_b64_tr_b16 v[48:49], v19 offset:0
    ds_read_b64_tr_b16 v[50:51], v19 offset:1024
    ds_read_b64_tr_b16 v[52:53], v20 offset:0
    ds_read_b64_tr_b16 v[54:55], v20 offset:1024
    ds_read_b128 v[40:43], v18 offset:0
    v_mfma_f32_32x32x16_bf16 v[96:111], v[152:155], v[140:143], v[96:111]
    ds_read_b128 v[44:47], v18 offset:4096
    ds_read_b64_tr_b16 v[56:57], v19 offset:4096
    ds_read_b64_tr_b16 v[58:59], v19 offset:5120
    ds_read_b64_tr_b16 v[60:61], v20 offset:4096
    ds_read_b64_tr_b16 v[62:63], v20 offset:5120
    v_mfma_f32_32x32x16_bf16 v[112:127], v[156:159], v[140:143], v[112:127]
    s_waitcnt vmcnt(12)
    s_waitcnt lgkmcnt(0)
    s_barrier
    v_mfma_f32_32x32x16_bf16 v[64:79], v[48:51], v[32:35], v[64:79]
    s_add_u32 m0, s24, 49152
    s_add_u32 s25, s38, 57344
    buffer_load_dwordx4 v3, s[8:11], s25 offen lds
    s_add_u32 m0, s24, 50176
    v_mfma_f32_32x32x16_bf16 v[80:95], v[52:55], v[32:35], v[80:95]
    s_add_u32 s25, s38, 64512
    buffer_load_dwordx4 v4, s[8:11], s25 offen lds
    s_mov_b32 s26, 57344
    s_mov_b32 s27, 65536
    v_mfma_f32_32x32x16_bf16 v[96:111], v[48:51], v[36:39], v[96:111]
    s_cmp_eq_u32 s28, 0
    s_cselect_b32 s26, s26, s27
    v_xor_b32 v17, 64, v12
    v_add_u32 v17, s26, v17
    v_mfma_f32_32x32x16_bf16 v[112:127], v[52:55], v[36:39], v[112:127]
    v_xor_b32 v18, 32, v17
    v_add_u32 v19, 73728, v15
    v_xor_b32 v20, 64, v19
    ds_read_b128 v[128:131], v17 offset:0
    v_mfma_f32_32x32x16_bf16 v[64:79], v[56:59], v[40:43], v[64:79]
    ds_read_b128 v[132:135], v17 offset:4096
    ds_read_b64_tr_b16 v[144:145], v19 offset:0
    ds_read_b64_tr_b16 v[146:147], v19 offset:1024
    ds_read_b64_tr_b16 v[148:149], v20 offset:0
    v_mfma_f32_32x32x16_bf16 v[80:95], v[60:63], v[40:43], v[80:95]
    ds_read_b64_tr_b16 v[150:151], v20 offset:1024
    ds_read_b128 v[136:139], v18 offset:0
    ds_read_b128 v[140:143], v18 offset:4096
    ds_read_b64_tr_b16 v[152:153], v19 offset:4096
    v_mfma_f32_32x32x16_bf16 v[96:111], v[56:59], v[44:47], v[96:111]
    ds_read_b64_tr_b16 v[154:155], v19 offset:5120
    ds_read_b64_tr_b16 v[156:157], v20 offset:4096
    ds_read_b64_tr_b16 v[158:159], v20 offset:5120
    v_mfma_f32_32x32x16_bf16 v[112:127], v[60:63], v[44:47], v[112:127]
    s_waitcnt vmcnt(8)
    s_waitcnt lgkmcnt(0)
    s_barrier
    v_mfma_f32_32x32x16_bf16 v[64:79], v[144:147], v[128:131], v[64:79]
    s_mul_i32 s30, s38, 1792
    s_add_u32 m0, s24, 57344
    s_add_u32 s25, s30, 114688
    buffer_load_dwordx4 v5, s[12:15], s25 offen lds
    v_mfma_f32_32x32x16_bf16 v[80:95], v[148:151], v[128:131], v[80:95]
    s_add_u32 m0, s24, 58368
    s_add_u32 s25, s30, 129024
    buffer_load_dwordx4 v5, s[12:15], s25 offen lds
    s_mov_b32 s26, 8192
    v_mfma_f32_32x32x16_bf16 v[96:111], v[144:147], v[132:135], v[96:111]
    s_mov_b32 s27, 16384
    s_cmp_eq_u32 s28, 0
    s_cselect_b32 s26, s26, s27
    v_xor_b32 v17, 0, v12
    v_mfma_f32_32x32x16_bf16 v[112:127], v[148:151], v[132:135], v[112:127]
    v_add_u32 v17, s26, v17
    v_xor_b32 v18, 32, v17
    v_add_u32 v19, 0, v15
    v_xor_b32 v20, 64, v19
    v_mfma_f32_32x32x16_bf16 v[64:79], v[152:155], v[136:139], v[64:79]
    ds_read_b128 v[32:35], v17 offset:0
    ds_read_b128 v[36:39], v17 offset:4096
    ds_read_b64_tr_b16 v[48:49], v19 offset:0
    ds_read_b64_tr_b16 v[50:51], v19 offset:1024
    v_mfma_f32_32x32x16_bf16 v[80:95], v[156:159], v[136:139], v[80:95]
    ds_read_b64_tr_b16 v[52:53], v20 offset:0
    ds_read_b64_tr_b16 v[54:55], v20 offset:1024
    ds_read_b128 v[40:43], v18 offset:0
    ds_read_b128 v[44:47], v18 offset:4096
    v_mfma_f32_32x32x16_bf16 v[96:111], v[152:155], v[140:143], v[96:111]
    ds_read_b64_tr_b16 v[56:57], v19 offset:4096
    ds_read_b64_tr_b16 v[58:59], v19 offset:5120
    ds_read_b64_tr_b16 v[60:61], v20 offset:4096
    ds_read_b64_tr_b16 v[62:63], v20 offset:5120
    v_mfma_f32_32x32x16_bf16 v[112:127], v[156:159], v[140:143], v[112:127]
    s_waitcnt vmcnt(8)
    s_waitcnt lgkmcnt(0)
    s_barrier
    v_mfma_f32_32x32x16_bf16 v[64:79], v[48:51], v[32:35], v[64:79]
    s_mov_b32 s26, 8192
    s_mov_b32 s27, 16384
    s_cmp_eq_u32 s28, 0
    v_mfma_f32_32x32x16_bf16 v[80:95], v[52:55], v[32:35], v[80:95]
    s_cselect_b32 s26, s26, s27
    v_xor_b32 v17, 64, v12
    v_add_u32 v17, s26, v17
    v_mfma_f32_32x32x16_bf16 v[96:111], v[48:51], v[36:39], v[96:111]
    v_xor_b32 v18, 32, v17
    v_add_u32 v19, 24576, v15
    v_xor_b32 v20, 64, v19
    v_mfma_f32_32x32x16_bf16 v[112:127], v[52:55], v[36:39], v[112:127]
    ds_read_b128 v[128:131], v17 offset:0
    ds_read_b128 v[132:135], v17 offset:4096
    ds_read_b64_tr_b16 v[144:145], v19 offset:0
    v_mfma_f32_32x32x16_bf16 v[64:79], v[56:59], v[40:43], v[64:79]
    ds_read_b64_tr_b16 v[146:147], v19 offset:1024
    ds_read_b64_tr_b16 v[148:149], v20 offset:0
    ds_read_b64_tr_b16 v[150:151], v20 offset:1024
    v_mfma_f32_32x32x16_bf16 v[80:95], v[60:63], v[40:43], v[80:95]
    ds_read_b128 v[136:139], v18 offset:0
    ds_read_b128 v[140:143], v18 offset:4096
    ds_read_b64_tr_b16 v[152:153], v19 offset:4096
    v_mfma_f32_32x32x16_bf16 v[96:111], v[56:59], v[44:47], v[96:111]
    ds_read_b64_tr_b16 v[154:155], v19 offset:5120
    ds_read_b64_tr_b16 v[156:157], v20 offset:4096
    ds_read_b64_tr_b16 v[158:159], v20 offset:5120
    v_mfma_f32_32x32x16_bf16 v[112:127], v[60:63], v[44:47], v[112:127]
    s_waitcnt vmcnt(2)
    s_waitcnt lgkmcnt(0)
    s_barrier
    v_mfma_f32_32x32x16_bf16 v[64:79], v[144:147], v[128:131], v[64:79]
    s_mov_b32 s26, 40960
    s_mov_b32 s27, 49152
    s_cmp_eq_u32 s28, 0
    v_mfma_f32_32x32x16_bf16 v[80:95], v[148:151], v[128:131], v[80:95]
    s_cselect_b32 s26, s26, s27
    v_xor_b32 v17, 0, v12
    v_add_u32 v17, s26, v17
    v_mfma_f32_32x32x16_bf16 v[96:111], v[144:147], v[132:135], v[96:111]
    v_xor_b32 v18, 32, v17
    v_add_u32 v19, 32768, v15
    v_xor_b32 v20, 64, v19
    v_mfma_f32_32x32x16_bf16 v[112:127], v[148:151], v[132:135], v[112:127]
    ds_read_b128 v[32:35], v17 offset:0
    ds_read_b128 v[36:39], v17 offset:4096
    ds_read_b64_tr_b16 v[48:49], v19 offset:0
    v_mfma_f32_32x32x16_bf16 v[64:79], v[152:155], v[136:139], v[64:79]
    ds_read_b64_tr_b16 v[50:51], v19 offset:1024
    ds_read_b64_tr_b16 v[52:53], v20 offset:0
    ds_read_b64_tr_b16 v[54:55], v20 offset:1024
    v_mfma_f32_32x32x16_bf16 v[80:95], v[156:159], v[136:139], v[80:95]
    ds_read_b128 v[40:43], v18 offset:0
    ds_read_b128 v[44:47], v18 offset:4096
    ds_read_b64_tr_b16 v[56:57], v19 offset:4096
    v_mfma_f32_32x32x16_bf16 v[96:111], v[152:155], v[140:143], v[96:111]
    ds_read_b64_tr_b16 v[58:59], v19 offset:5120
    ds_read_b64_tr_b16 v[60:61], v20 offset:4096
    ds_read_b64_tr_b16 v[62:63], v20 offset:5120
    v_mfma_f32_32x32x16_bf16 v[112:127], v[156:159], v[140:143], v[112:127]
    s_waitcnt vmcnt(0)
    s_waitcnt lgkmcnt(0)
    s_barrier
    v_mfma_f32_32x32x16_bf16 v[64:79], v[48:51], v[32:35], v[64:79]
    s_mov_b32 s26, 40960
    s_mov_b32 s27, 49152
    s_cmp_eq_u32 s28, 0
    v_mfma_f32_32x32x16_bf16 v[80:95], v[52:55], v[32:35], v[80:95]
    s_cselect_b32 s26, s26, s27
    v_xor_b32 v17, 64, v12
    v_add_u32 v17, s26, v17
    v_mfma_f32_32x32x16_bf16 v[96:111], v[48:51], v[36:39], v[96:111]
    v_xor_b32 v18, 32, v17
    v_add_u32 v19, 57344, v15
    v_xor_b32 v20, 64, v19
    v_mfma_f32_32x32x16_bf16 v[112:127], v[52:55], v[36:39], v[112:127]
    ds_read_b128 v[128:131], v17 offset:0
    ds_read_b128 v[132:135], v17 offset:4096
    ds_read_b64_tr_b16 v[144:145], v19 offset:0
    v_mfma_f32_32x32x16_bf16 v[64:79], v[56:59], v[40:43], v[64:79]
    ds_read_b64_tr_b16 v[146:147], v19 offset:1024
    ds_read_b64_tr_b16 v[148:149], v20 offset:0
    ds_read_b64_tr_b16 v[150:151], v20 offset:1024
    v_mfma_f32_32x32x16_bf16 v[80:95], v[60:63], v[40:43], v[80:95]
    ds_read_b128 v[136:139], v18 offset:0
    ds_read_b128 v[140:143], v18 offset:4096
    ds_read_b64_tr_b16 v[152:153], v19 offset:4096
    v_mfma_f32_32x32x16_bf16 v[96:111], v[56:59], v[44:47], v[96:111]
    ds_read_b64_tr_b16 v[154:155], v19 offset:5120
    ds_read_b64_tr_b16 v[156:157], v20 offset:4096
    ds_read_b64_tr_b16 v[158:159], v20 offset:5120
    v_mfma_f32_32x32x16_bf16 v[112:127], v[60:63], v[44:47], v[112:127]
    s_waitcnt lgkmcnt(0)
    s_barrier
    v_mfma_f32_32x32x16_bf16 v[64:79], v[144:147], v[128:131], v[64:79]
    v_mfma_f32_32x32x16_bf16 v[80:95], v[148:151], v[128:131], v[80:95]
    v_mfma_f32_32x32x16_bf16 v[96:111], v[144:147], v[132:135], v[96:111]
    v_mfma_f32_32x32x16_bf16 v[112:127], v[148:151], v[132:135], v[112:127]
    v_mfma_f32_32x32x16_bf16 v[64:79], v[152:155], v[136:139], v[64:79]
    v_mfma_f32_32x32x16_bf16 v[80:95], v[156:159], v[136:139], v[80:95]
    v_mfma_f32_32x32x16_bf16 v[96:111], v[152:155], v[140:143], v[96:111]
    v_mfma_f32_32x32x16_bf16 v[112:127], v[156:159], v[140:143], v[112:127]
    s_nop 15
    s_barrier
    v_lshl_add_u32 v20, v10, 6, v8
    v_mul_u32_u24 v20, 272, v20
    v_lshl_add_u32 v20, v11, 7, v20
    v_lshl_add_u32 v20, v9, 3, v20
    v_max_f32 v64, 0, v64
    v_max_f32 v65, 0, v65
    v_max_f32 v66, 0, v66
    v_max_f32 v67, 0, v67
    v_cvt_pk_bf16_f32 v48, v64, v65
    v_cvt_pk_bf16_f32 v49, v66, v67
    ds_write_b64 v20, v[48:49] offset:0
    v_max_f32 v68, 0, v68
    v_max_f32 v69, 0, v69
    v_max_f32 v70, 0, v70
    v_max_f32 v71, 0, v71
    v_cvt_pk_bf16_f32 v50, v68, v69
    v_cvt_pk_bf16_f32 v51, v70, v71
    ds_write_b64 v20, v[50:51] offset:16
    v_max_f32 v72, 0, v72
    v_max_f32 v73, 0, v73
    v_max_f32 v74, 0, v74
    v_max_f32 v75, 0, v75
    v_cvt_pk_bf16_f32 v52, v72, v73
    v_cvt_pk_bf16_f32 v53, v74, v75
    ds_write_b64 v20, v[52:53] offset:32
    v_max_f32 v76, 0, v76
    v_max_f32 v77, 0, v77
    v_max_f32 v78, 0, v78
    v_max_f32 v79, 0, v79
    v_cvt_pk_bf16_f32 v54, v76, v77
    v_cvt_pk_bf16_f32 v55, v78, v79
    ds_write_b64 v20, v[54:55] offset:48
    v_max_f32 v80, 0, v80
    v_max_f32 v81, 0, v81
    v_max_f32 v82, 0, v82
    v_max_f32 v83, 0, v83
    v_cvt_pk_bf16_f32 v48, v80, v81
    v_cvt_pk_bf16_f32 v49, v82, v83
    ds_write_b64 v20, v[48:49] offset:64
    v_max_f32 v84, 0, v84
    v_max_f32 v85, 0, v85
    v_max_f32 v86, 0, v86
    v_max_f32 v87, 0, v87
    v_cvt_pk_bf16_f32 v50, v84, v85
    v_cvt_pk_bf16_f32 v51, v86, v87
    ds_write_b64 v20, v[50:51] offset:80
    v_max_f32 v88, 0, v88
    v_max_f32 v89, 0, v89
    v_max_f32 v90, 0, v90
    v_max_f32 v91, 0, v91
    v_cvt_pk_bf16_f32 v52, v88, v89
    v_cvt_pk_bf16_f32 v53, v90, v91
    ds_write_b64 v20, v[52:53] offset:96
    v_max_f32 v92, 0, v92
    v_max_f32 v93, 0, v93
    v_max_f32 v94, 0, v94
    v_max_f32 v95, 0, v95
    v_cvt_pk_bf16_f32 v54, v92, v93
    v_cvt_pk_bf16_f32 v55, v94, v95
    ds_write_b64 v20, v[54:55] offset:112
    v_max_f32 v96, 0, v96
    v_max_f32 v97, 0, v97
    v_max_f32 v98, 0, v98
    v_max_f32 v99, 0, v99
    v_cvt_pk_bf16_f32 v48, v96, v97
    v_cvt_pk_bf16_f32 v49, v98, v99
    ds_write_b64 v20, v[48:49] offset:8704
    v_max_f32 v100, 0, v100
    v_max_f32 v101, 0, v101
    v_max_f32 v102, 0, v102
    v_max_f32 v103, 0, v103
    v_cvt_pk_bf16_f32 v50, v100, v101
    v_cvt_pk_bf16_f32 v51, v102, v103
    ds_write_b64 v20, v[50:51] offset:8720
    v_max_f32 v104, 0, v104
    v_max_f32 v105, 0, v105
    v_max_f32 v106, 0, v106
    v_max_f32 v107, 0, v107
    v_cvt_pk_bf16_f32 v52, v104, v105
    v_cvt_pk_bf16_f32 v53, v106, v107
    ds_write_b64 v20, v[52:53] offset:8736
    v_max_f32 v108, 0, v108
    v_max_f32 v109, 0, v109
    v_max_f32 v110, 0, v110
    v_max_f32 v111, 0, v111
    v_cvt_pk_bf16_f32 v54, v108, v109
    v_cvt_pk_bf16_f32 v55, v110, v111
    ds_write_b64 v20, v[54:55] offset:8752
    v_max_f32 v112, 0, v112
    v_max_f32 v113, 0, v113
    v_max_f32 v114, 0, v114
    v_max_f32 v115, 0, v115
    v_cvt_pk_bf16_f32 v48, v112, v113
    v_cvt_pk_bf16_f32 v49, v114, v115
    ds_write_b64 v20, v[48:49] offset:8768
    v_max_f32 v116, 0, v116
    v_max_f32 v117, 0, v117
    v_max_f32 v118, 0, v118
    v_max_f32 v119, 0, v119
    v_cvt_pk_bf16_f32 v50, v116, v117
    v_cvt_pk_bf16_f32 v51, v118, v119
    ds_write_b64 v20, v[50:51] offset:8784
    v_max_f32 v120, 0, v120
    v_max_f32 v121, 0, v121
    v_max_f32 v122, 0, v122
    v_max_f32 v123, 0, v123
    v_cvt_pk_bf16_f32 v52, v120, v121
    v_cvt_pk_bf16_f32 v53, v122, v123
    ds_write_b64 v20, v[52:53] offset:8800
    v_max_f32 v124, 0, v124
    v_max_f32 v125, 0, v125
    v_max_f32 v126, 0, v126
    v_max_f32 v127, 0, v127
    v_cvt_pk_bf16_f32 v54, v124, v125
    v_cvt_pk_bf16_f32 v55, v126, v127
    ds_write_b64 v20, v[54:55] offset:8816
    s_waitcnt lgkmcnt(0)
    s_barrier
    v_lshrrev_b32 v21, 4, v0
    v_and_b32 v22, 15, v0
    v_mul_u32_u24 v23, 272, v21
    v_lshl_add_u32 v23, v22, 4, v23
    ds_read_b128 v[64:67], v23 offset:0
    ds_read_b128 v[68:71], v23 offset:4352
    ds_read_b128 v[72:75], v23 offset:8704
    ds_read_b128 v[76:79], v23 offset:13056
    ds_read_b128 v[80:83], v23 offset:17408
    ds_read_b128 v[84:87], v23 offset:21760
    ds_read_b128 v[88:91], v23 offset:26112
    ds_read_b128 v[92:95], v23 offset:30464
    s_lshl_b32 s23, s20, 7
    v_add_u32 v21, s23, v21
    v_mul_u32_u24 v21, 3584, v21
    v_lshl_add_u32 v21, v22, 4, v21
    s_lshl_b32 s23, s21, 8
    v_add_u32 v21, s23, v21
    s_mov_b32 s25, 0
    s_waitcnt lgkmcnt(7)
    buffer_store_dwordx4 v[64:67], v21, s[16:19], s25 offen sc1
    s_mov_b32 s25, 57344
    s_waitcnt lgkmcnt(6)
    buffer_store_dwordx4 v[68:71], v21, s[16:19], s25 offen sc1
    s_mov_b32 s25, 114688
    s_waitcnt lgkmcnt(5)
    buffer_store_dwordx4 v[72:75], v21, s[16:19], s25 offen sc1
    s_mov_b32 s25, 172032
    s_waitcnt lgkmcnt(4)
    buffer_store_dwordx4 v[76:79], v21, s[16:19], s25 offen sc1
    s_mov_b32 s25, 229376
    s_waitcnt lgkmcnt(3)
    buffer_store_dwordx4 v[80:83], v21, s[16:19], s25 offen sc1
    s_mov_b32 s25, 286720
    s_waitcnt lgkmcnt(2)
    buffer_store_dwordx4 v[84:87], v21, s[16:19], s25 offen sc1
    s_mov_b32 s25, 344064
    s_waitcnt lgkmcnt(1)
    buffer_store_dwordx4 v[88:91], v21, s[16:19], s25 offen sc1
    s_mov_b32 s25, 401408
    s_waitcnt lgkmcnt(0)
    buffer_store_dwordx4 v[92:95], v21, s[16:19], s25 offen sc1
    s_waitcnt vmcnt(0)
    s_barrier
    s_add_u32 s52, s6, 18886656
    s_addc_u32 s53, s7, 0
    s_mov_b32 s54, 4096
    s_mov_b32 s55, 0x00020000
    s_lshl_b32 s23, s20, 8
    s_lshl_b32 s30, s21, 2
    s_add_u32 s23, s23, s30
    v_mov_b32 v4, s23
    v_mov_b32 v5, 1
    v_cmp_eq_u32 vcc, 0, v0
    s_and_saveexec_b64 s[30:31], vcc
    buffer_store_dword v5, v4, s[52:55], 0 offen sc1
    s_mov_b64 exec, s[30:31]
    s_mov_b32 s34, s20
    s_mov_b32 s35, s21
    s_add_u32 s8, s6, 6291456
    s_addc_u32 s9, s7, 0
    s_mov_b32 s10, 7340032
    s_mov_b32 s11, 0x00020000
    s_add_u32 s16, s6, 14680064
    s_addc_u32 s17, s7, 0
    s_mov_b32 s18, 1835008
    s_mov_b32 s19, 0x00020000
    s_mov_b32 s12, s82
    s_mov_b32 s13, s83
    s_mov_b32 s14, 1605632
    s_mov_b32 s15, 0x00020000
    s_mov_b32 s40, s64
    s_mov_b32 s41, s65
    s_mov_b32 s42, 1835008
    s_mov_b32 s43, 0x00020000
    s_mov_b32 s44, s84
    s_mov_b32 s45, s85
    s_mov_b32 s46, 1835008
    s_mov_b32 s47, 0x00020000
    s_cmp_ge_u32 s35, 7
    s_cselect_b32 s26, 1, 0
    s_lshl_b32 s20, s34, 1
    s_add_u32 s20, s20, s26
    s_mul_i32 s26, s26, 7
    s_sub_u32 s21, s35, s26
    s_lshl_b32 s31, s35, 1
    v_lshrrev_b32 v3, 3, v1
    v_lshl_add_u32 v3, v2, 4, v3
    s_lshl_b32 s23, s20, 6
    v_add_u32 v3, s23, v3
    v_mul_u32_u24 v3, 3584, v3
    v_and_b32 v4, 7, v1
    v_lshrrev_b32 v5, 4, v1
    v_xor_b32 v4, v4, v5
    v_lshl_add_u32 v3, v4, 4, v3
    v_xor_b32 v4, 64, v3
    v_lshrrev_b32 v5, 3, v1
    v_lshl_add_u32 v5, v2, 4, v5
    v_mul_u32_u24 v5, 896, v5
    v_bfe_u32 v6, v1, 2, 1
    v_bfe_u32 v7, v1, 4, 1
    v_xor_b32 v6, v6, v7
    v_and_b32 v7, 3, v1
    v_lshl_add_u32 v6, v6, 2, v7
    v_lshl_add_u32 v5, v6, 4, v5
    s_lshl_b32 s23, s21, 7
    v_add_u32 v5, s23, v5
    s_lshl_b32 s24, s22, 11

    s_mov_b32 s32, s31
    s_mov_b32 s33, s31
    s_mul_i32 s27, s33, 57344
    s_add_u32 m0, s24, 8192
    s_add_u32 s25, s27, 0
    buffer_load_dwordx4 v5, s[12:15], s25 offen lds
    s_add_u32 m0, s24, 9216
    s_add_u32 s25, s27, 7168
    buffer_load_dwordx4 v5, s[12:15], s25 offen lds
    s_add_u32 s33, s33, 1
    s_cmp_eq_u32 s33, 28
    s_cselect_b32 s33, 0, s33
    s_mul_i32 s27, s33, 57344
    s_add_u32 m0, s24, 24576
    s_add_u32 s25, s27, 0
    buffer_load_dwordx4 v5, s[12:15], s25 offen lds
    s_add_u32 m0, s24, 25600
    s_add_u32 s25, s27, 7168
    buffer_load_dwordx4 v5, s[12:15], s25 offen lds
    s_add_u32 s33, s33, 1
    s_cmp_eq_u32 s33, 28
    s_cselect_b32 s33, 0, s33
    s_mul_i32 s27, s33, 57344
    s_add_u32 m0, s24, 40960
    s_add_u32 s25, s27, 0
    buffer_load_dwordx4 v5, s[12:15], s25 offen lds
    s_add_u32 m0, s24, 41984
    s_add_u32 s25, s27, 7168
    buffer_load_dwordx4 v5, s[12:15], s25 offen lds
    s_add_u32 s33, s33, 1
    s_cmp_eq_u32 s33, 28
    s_cselect_b32 s33, 0, s33
    s_mul_i32 s27, s33, 57344
    s_add_u32 m0, s24, 57344
    s_add_u32 s25, s27, 0
    buffer_load_dwordx4 v5, s[12:15], s25 offen lds
    s_add_u32 m0, s24, 58368
    s_add_u32 s25, s27, 7168
    buffer_load_dwordx4 v5, s[12:15], s25 offen lds
    s_add_u32 s33, s33, 1
    s_cmp_eq_u32 s33, 28
    s_cselect_b32 s33, 0, s33
    s_mul_i32 s27, s33, 57344
    s_add_u32 m0, s24, 73728
    s_add_u32 s25, s27, 0
    buffer_load_dwordx4 v5, s[12:15], s25 offen lds
    s_add_u32 m0, s24, 74752
    s_add_u32 s25, s27, 7168
    buffer_load_dwordx4 v5, s[12:15], s25 offen lds
    s_add_u32 s33, s33, 1
    s_cmp_eq_u32 s33, 28
    s_cselect_b32 s33, 0, s33
    s_add_u32 s52, s6, 18886656
    s_addc_u32 s53, s7, 0
    s_mov_b32 s54, 8192
    s_mov_b32 s55, 0x00020000
    s_lshl_b32 s23, s34, 8
    v_lshlrev_b32 v23, 2, v1
    v_add_u32 v23, s23, v23
    s_mov_b32 s36, 0
    s_mov_b32 s39, 0
    s_bitset1_b32 s36, s35
    s_lshr_b32 s26, s32, 1
    s_bitcmp1_b32 s36, s26
    s_cbranch_scc0 L_g2_slow_14
L_g2_back_15:
    s_lshl_b32 s26, s32, 7
    s_add_u32 m0, s24, 0
    s_add_u32 s25, s26, 0
    buffer_load_dwordx4 v3, s[8:11], s25 offen lds
    s_add_u32 m0, s24, 1024
    s_add_u32 s25, s26, 28672
    buffer_load_dwordx4 v4, s[8:11], s25 offen lds
    s_add_u32 s32, s32, 1
    s_cmp_eq_u32 s32, 28
    s_cselect_b32 s32, 0, s32
    s_lshl_b32 s26, s32, 7
    s_add_u32 m0, s24, 16384
    s_add_u32 s25, s26, 0
    buffer_load_dwordx4 v3, s[8:11], s25 offen lds
    s_add_u32 m0, s24, 17408
    s_add_u32 s25, s26, 28672
    buffer_load_dwordx4 v4, s[8:11], s25 offen lds
    s_add_u32 s32, s32, 1
    s_cmp_eq_u32 s32, 28
    s_cselect_b32 s32, 0, s32
    s_lshr_b32 s26, s32, 1
    s_bitcmp1_b32 s36, s26
    s_cbranch_scc0 L_g2_slow_16
L_g2_back_17:
    s_lshl_b32 s26, s32, 7
    s_add_u32 m0, s24, 32768
    s_add_u32 s25, s26, 0
    buffer_load_dwordx4 v3, s[8:11], s25 offen lds
    s_add_u32 m0, s24, 33792
    s_add_u32 s25, s26, 28672
    buffer_load_dwordx4 v4, s[8:11], s25 offen lds
    s_add_u32 s32, s32, 1
    s_cmp_eq_u32 s32, 28
    s_cselect_b32 s32, 0, s32
    s_lshl_b32 s26, s32, 7
    s_add_u32 m0, s24, 49152
    s_add_u32 s25, s26, 0
    buffer_load_dwordx4 v3, s[8:11], s25 offen lds
    s_add_u32 m0, s24, 50176
    s_add_u32 s25, s26, 28672
    buffer_load_dwordx4 v4, s[8:11], s25 offen lds
    s_add_u32 s32, s32, 1
    s_cmp_eq_u32 s32, 28
    s_cselect_b32 s32, 0, s32
    s_lshr_b32 s26, s32, 1
    s_bitcmp1_b32 s36, s26
    s_cbranch_scc0 L_g2_slow_18
L_g2_back_19:
    s_lshl_b32 s26, s32, 7
    s_add_u32 m0, s24, 65536
    s_add_u32 s25, s26, 0
    buffer_load_dwordx4 v3, s[8:11], s25 offen lds
    s_add_u32 m0, s24, 66560
    s_add_u32 s25, s26, 28672
    buffer_load_dwordx4 v4, s[8:11], s25 offen lds
    s_add_u32 s32, s32, 1
    s_cmp_eq_u32 s32, 28
    s_cselect_b32 s32, 0, s32
    s_lshl_b32 s23, s20, 6
    v_add_u32 v22, s23, v1
    v_mul_u32_u24 v22, 896, v22
    v_lshl_add_u32 v22, v2, 5, v22
    s_lshl_b32 s23, s21, 7
    v_add_u32 v22, s23, v22
    buffer_load_dwordx4 v[24:27], v22, s[40:43], 0 offen
    buffer_load_dwordx4 v[28:31], v22, s[40:43], 0 offen offset:16

    v_and_b32 v8, 31, v1
    v_lshrrev_b32 v9, 5, v1
    v_lshlrev_b32 v12, 7, v8
    v_lshl_add_u32 v13, v2, 1, v9
    v_bfe_u32 v14, v8, 1, 3
    v_xor_b32 v13, v13, v14
    v_lshl_add_u32 v12, v13, 4, v12
    v_add_u32 v13, 0x10000, v12
    v_bfe_u32 v14, v1, 2, 2
    v_lshl_add_u32 v15, v9, 3, v14
    v_lshl_add_u32 v15, v2, 4, v15
    v_lshlrev_b32 v15, 7, v15
    v_lshrrev_b32 v16, 1, v14
    v_lshl_add_u32 v15, v16, 6, v15
    v_bfe_u32 v16, v1, 4, 1
    v_lshl_add_u32 v15, v16, 5, v15
    v_and_b32 v16, 3, v1
    v_lshl_add_u32 v15, v16, 3, v15
    v_add_u32 v15, 8192, v15
    v_xor_b32 v16, 64, v15
    v_add_u32 v10, 0x10000, v15
    v_add_u32 v11, 0x10000, v16

    v_mov_b32 v64, 0
    v_mov_b32 v65, 0
    v_mov_b32 v66, 0
    v_mov_b32 v67, 0
    v_mov_b32 v68, 0
    v_mov_b32 v69, 0
    v_mov_b32 v70, 0
    v_mov_b32 v71, 0
    v_mov_b32 v72, 0
    v_mov_b32 v73, 0
    v_mov_b32 v74, 0
    v_mov_b32 v75, 0
    v_mov_b32 v76, 0
    v_mov_b32 v77, 0
    v_mov_b32 v78, 0
    v_mov_b32 v79, 0
    v_mov_b32 v80, 0
    v_mov_b32 v81, 0
    v_mov_b32 v82, 0
    v_mov_b32 v83, 0
    v_mov_b32 v84, 0
    v_mov_b32 v85, 0
    v_mov_b32 v86, 0
    v_mov_b32 v87, 0
    v_mov_b32 v88, 0
    v_mov_b32 v89, 0
    v_mov_b32 v90, 0
    v_mov_b32 v91, 0
    v_mov_b32 v92, 0
    v_mov_b32 v93, 0
    v_mov_b32 v94, 0
    v_mov_b32 v95, 0
    v_mov_b32 v96, 0
    v_mov_b32 v97, 0
    v_mov_b32 v98, 0
    v_mov_b32 v99, 0
    v_mov_b32 v100, 0
    v_mov_b32 v101, 0
    v_mov_b32 v102, 0
    v_mov_b32 v103, 0
    v_mov_b32 v104, 0
    v_mov_b32 v105, 0
    v_mov_b32 v106, 0
    v_mov_b32 v107, 0
    v_mov_b32 v108, 0
    v_mov_b32 v109, 0
    v_mov_b32 v110, 0
    v_mov_b32 v111, 0
    v_mov_b32 v112, 0
    v_mov_b32 v113, 0
    v_mov_b32 v114, 0
    v_mov_b32 v115, 0
    v_mov_b32 v116, 0
    v_mov_b32 v117, 0
    v_mov_b32 v118, 0
    v_mov_b32 v119, 0
    v_mov_b32 v120, 0
    v_mov_b32 v121, 0
    v_mov_b32 v122, 0
    v_mov_b32 v123, 0
    v_mov_b32 v124, 0
    v_mov_b32 v125, 0
    v_mov_b32 v126, 0
    v_mov_b32 v127, 0
    s_lshl_b32 s23, s21, 6
    v_lshlrev_b32 v17, 4, v2
    v_add_u32 v17, s23, v17
    v_lshlrev_b32 v17, 12, v17
    v_lshl_add_u32 v17, v1, 1, v17
    s_lshl_b32 s23, s20, 7
    v_add_u32 v17, s23, v17
    s_lshl_b32 s23, s21, 2
    v_mov_b32 v19, s23

    s_waitcnt vmcnt(10)
    s_barrier
    v_add_u32 v13, 0, v12
    v_add_u32 v10, 0, v15
    v_add_u32 v11, 0, v16
    ds_read_b128 v[32:35], v13 offset:0
    ds_read_b128 v[36:39], v13 offset:4096
    ds_read_b64_tr_b16 v[40:41], v10 offset:0
    ds_read_b64_tr_b16 v[42:43], v10 offset:512
    ds_read_b64_tr_b16 v[44:45], v11 offset:0
    ds_read_b64_tr_b16 v[46:47], v11 offset:512
    s_waitcnt vmcnt(8)
    s_waitcnt lgkmcnt(0)
    s_barrier
    v_mfma_f32_32x32x16_bf16 v[64:79], v[40:43], v[32:35], v[64:79]
    s_lshl_b32 s26, s32, 7
    s_add_u32 m0, s24, 0
    s_add_u32 s25, s26, 0
    buffer_load_dwordx4 v3, s[8:11], s25 offen lds
    s_add_u32 m0, s24, 1024
    s_add_u32 s25, s26, 28672
    buffer_load_dwordx4 v4, s[8:11], s25 offen lds
    s_add_u32 s32, s32, 1
    v_mfma_f32_32x32x16_bf16 v[80:95], v[44:47], v[32:35], v[80:95]
    s_cmp_eq_u32 s32, 28
    s_cselect_b32 s32, 0, s32
    s_mul_i32 s27, s33, 57344
    s_add_u32 m0, s24, 8192
    s_add_u32 s25, s27, 0
    buffer_load_dwordx4 v5, s[12:15], s25 offen lds
    s_add_u32 m0, s24, 9216
    s_add_u32 s25, s27, 7168
    v_mfma_f32_32x32x16_bf16 v[96:111], v[40:43], v[36:39], v[96:111]
    buffer_load_dwordx4 v5, s[12:15], s25 offen lds
    s_add_u32 s33, s33, 1
    s_cmp_eq_u32 s33, 28
    s_cselect_b32 s33, 0, s33
    v_add_u32 v13, 16384, v12
    v_add_u32 v10, 16384, v15
    v_add_u32 v11, 16384, v16
    ds_read_b128 v[128:131], v13 offset:0
    v_mfma_f32_32x32x16_bf16 v[112:127], v[44:47], v[36:39], v[112:127]
    ds_read_b128 v[132:135], v13 offset:4096
    ds_read_b64_tr_b16 v[136:137], v10 offset:0
    ds_read_b64_tr_b16 v[138:139], v10 offset:512
    ds_read_b64_tr_b16 v[140:141], v11 offset:0
    ds_read_b64_tr_b16 v[142:143], v11 offset:512
    s_waitcnt vmcnt(10)
    s_waitcnt lgkmcnt(0)
    s_barrier
    v_mfma_f32_32x32x16_bf16 v[64:79], v[136:139], v[128:131], v[64:79]
    s_lshr_b32 s26, s32, 1
    s_bitcmp1_b32 s36, s26
    s_cbranch_scc0 L_g2_slow_20
L_g2_back_21:
    s_lshl_b32 s26, s32, 7
    s_add_u32 m0, s24, 16384
    s_add_u32 s25, s26, 0
    buffer_load_dwordx4 v3, s[8:11], s25 offen lds
    s_add_u32 m0, s24, 17408
    v_mfma_f32_32x32x16_bf16 v[80:95], v[140:143], v[128:131], v[80:95]
    s_add_u32 s25, s26, 28672
    buffer_load_dwordx4 v4, s[8:11], s25 offen lds
    s_add_u32 s32, s32, 1
    s_cmp_eq_u32 s32, 28
    s_cselect_b32 s32, 0, s32
    s_mul_i32 s27, s33, 57344
    s_add_u32 m0, s24, 24576
    s_add_u32 s25, s27, 0
    buffer_load_dwordx4 v5, s[12:15], s25 offen lds
    v_mfma_f32_32x32x16_bf16 v[96:111], v[136:139], v[132:135], v[96:111]
    s_add_u32 m0, s24, 25600
    s_add_u32 s25, s27, 7168
    buffer_load_dwordx4 v5, s[12:15], s25 offen lds
    s_add_u32 s33, s33, 1
    s_cmp_eq_u32 s33, 28
    s_cselect_b32 s33, 0, s33
    v_add_u32 v13, 32768, v12
    v_add_u32 v10, 32768, v15
    v_add_u32 v11, 32768, v16
    v_mfma_f32_32x32x16_bf16 v[112:127], v[140:143], v[132:135], v[112:127]
    ds_read_b128 v[32:35], v13 offset:0
    ds_read_b128 v[36:39], v13 offset:4096
    ds_read_b64_tr_b16 v[40:41], v10 offset:0
    ds_read_b64_tr_b16 v[42:43], v10 offset:512
    ds_read_b64_tr_b16 v[44:45], v11 offset:0
    ds_read_b64_tr_b16 v[46:47], v11 offset:512
    s_waitcnt vmcnt(12)
    s_waitcnt lgkmcnt(0)
    s_barrier
    v_mfma_f32_32x32x16_bf16 v[64:79], v[40:43], v[32:35], v[64:79]
    s_lshl_b32 s26, s32, 7
    s_add_u32 m0, s24, 32768
    s_add_u32 s25, s26, 0
    buffer_load_dwordx4 v3, s[8:11], s25 offen lds
    s_add_u32 m0, s24, 33792
    s_add_u32 s25, s26, 28672
    buffer_load_dwordx4 v4, s[8:11], s25 offen lds
    s_add_u32 s32, s32, 1
    v_mfma_f32_32x32x16_bf16 v[80:95], v[44:47], v[32:35], v[80:95]
    s_cmp_eq_u32 s32, 28
    s_cselect_b32 s32, 0, s32
    s_mul_i32 s27, s33, 57344
    s_add_u32 m0, s24, 40960
    s_add_u32 s25, s27, 0
    buffer_load_dwordx4 v5, s[12:15], s25 offen lds
    s_add_u32 m0, s24, 41984
    s_add_u32 s25, s27, 7168
    v_mfma_f32_32x32x16_bf16 v[96:111], v[40:43], v[36:39], v[96:111]
    buffer_load_dwordx4 v5, s[12:15], s25 offen lds
    s_add_u32 s33, s33, 1
    s_cmp_eq_u32 s33, 28
    s_cselect_b32 s33, 0, s33
    v_add_u32 v13, 49152, v12
    v_add_u32 v10, 49152, v15
    v_add_u32 v11, 49152, v16
    ds_read_b128 v[128:131], v13 offset:0
    v_mfma_f32_32x32x16_bf16 v[112:127], v[44:47], v[36:39], v[112:127]
    ds_read_b128 v[132:135], v13 offset:4096
    ds_read_b64_tr_b16 v[136:137], v10 offset:0
    ds_read_b64_tr_b16 v[138:139], v10 offset:512
    ds_read_b64_tr_b16 v[140:141], v11 offset:0
    ds_read_b64_tr_b16 v[142:143], v11 offset:512
    s_waitcnt vmcnt(14)
    s_waitcnt lgkmcnt(0)
    s_barrier
    v_mfma_f32_32x32x16_bf16 v[64:79], v[136:139], v[128:131], v[64:79]
    s_lshr_b32 s26, s32, 1
    s_bitcmp1_b32 s36, s26
    s_cbranch_scc0 L_g2_slow_22
L_g2_back_23:
    s_lshl_b32 s26, s32, 7
    s_add_u32 m0, s24, 49152
    s_add_u32 s25, s26, 0
    buffer_load_dwordx4 v3, s[8:11], s25 offen lds
    s_add_u32 m0, s24, 50176
    v_mfma_f32_32x32x16_bf16 v[80:95], v[140:143], v[128:131], v[80:95]
    s_add_u32 s25, s26, 28672
    buffer_load_dwordx4 v4, s[8:11], s25 offen lds
    s_add_u32 s32, s32, 1
    s_cmp_eq_u32 s32, 28
    s_cselect_b32 s32, 0, s32
    s_mul_i32 s27, s33, 57344
    s_add_u32 m0, s24, 57344
    s_add_u32 s25, s27, 0
    buffer_load_dwordx4 v5, s[12:15], s25 offen lds
    v_mfma_f32_32x32x16_bf16 v[96:111], v[136:139], v[132:135], v[96:111]
    s_add_u32 m0, s24, 58368
    s_add_u32 s25, s27, 7168
    buffer_load_dwordx4 v5, s[12:15], s25 offen lds
    s_add_u32 s33, s33, 1
    s_cmp_eq_u32 s33, 28
    s_cselect_b32 s33, 0, s33
    v_add_u32 v13, 65536, v12
    v_add_u32 v10, 65536, v15
    v_add_u32 v11, 65536, v16
    v_mfma_f32_32x32x16_bf16 v[112:127], v[140:143], v[132:135], v[112:127]
    ds_read_b128 v[32:35], v13 offset:0
    ds_read_b128 v[36:39], v13 offset:4096
    ds_read_b64_tr_b16 v[40:41], v10 offset:0
    ds_read_b64_tr_b16 v[42:43], v10 offset:512
    ds_read_b64_tr_b16 v[44:45], v11 offset:0
    ds_read_b64_tr_b16 v[46:47], v11 offset:512
    s_waitcnt vmcnt(12)
    s_waitcnt lgkmcnt(0)
    s_barrier
    v_mfma_f32_32x32x16_bf16 v[64:79], v[40:43], v[32:35], v[64:79]
    s_lshl_b32 s26, s32, 7
    s_add_u32 m0, s24, 65536
    s_add_u32 s25, s26, 0
    buffer_load_dwordx4 v3, s[8:11], s25 offen lds
    s_add_u32 m0, s24, 66560
    s_add_u32 s25, s26, 28672
    buffer_load_dwordx4 v4, s[8:11], s25 offen lds
    s_add_u32 s32, s32, 1
    v_mfma_f32_32x32x16_bf16 v[80:95], v[44:47], v[32:35], v[80:95]
    s_cmp_eq_u32 s32, 28
    s_cselect_b32 s32, 0, s32
    s_mul_i32 s27, s33, 57344
    s_add_u32 m0, s24, 73728
    s_add_u32 s25, s27, 0
    buffer_load_dwordx4 v5, s[12:15], s25 offen lds
    s_add_u32 m0, s24, 74752
    s_add_u32 s25, s27, 7168
    v_mfma_f32_32x32x16_bf16 v[96:111], v[40:43], v[36:39], v[96:111]
    buffer_load_dwordx4 v5, s[12:15], s25 offen lds
    s_add_u32 s33, s33, 1
    s_cmp_eq_u32 s33, 28
    s_cselect_b32 s33, 0, s33
    v_add_u32 v13, 0, v12
    v_add_u32 v10, 0, v15
    v_add_u32 v11, 0, v16
    ds_read_b128 v[128:131], v13 offset:0
    v_mfma_f32_32x32x16_bf16 v[112:127], v[44:47], v[36:39], v[112:127]
    ds_read_b128 v[132:135], v13 offset:4096
    ds_read_b64_tr_b16 v[136:137], v10 offset:0
    ds_read_b64_tr_b16 v[138:139], v10 offset:512
    ds_read_b64_tr_b16 v[140:141], v11 offset:0
    ds_read_b64_tr_b16 v[142:143], v11 offset:512
    s_waitcnt vmcnt(12)
    s_waitcnt lgkmcnt(0)
    s_barrier
    v_mfma_f32_32x32x16_bf16 v[64:79], v[136:139], v[128:131], v[64:79]
    s_lshr_b32 s26, s32, 1
    s_bitcmp1_b32 s36, s26
    s_cbranch_scc0 L_g2_slow_24
L_g2_back_25:
    s_lshl_b32 s26, s32, 7
    s_add_u32 m0, s24, 0
    s_add_u32 s25, s26, 0
    buffer_load_dwordx4 v3, s[8:11], s25 offen lds
    s_add_u32 m0, s24, 1024
    v_mfma_f32_32x32x16_bf16 v[80:95], v[140:143], v[128:131], v[80:95]
    s_add_u32 s25, s26, 28672
    buffer_load_dwordx4 v4, s[8:11], s25 offen lds
    s_add_u32 s32, s32, 1
    s_cmp_eq_u32 s32, 28
    s_cselect_b32 s32, 0, s32
    s_mul_i32 s27, s33, 57344
    s_add_u32 m0, s24, 8192
    s_add_u32 s25, s27, 0
    buffer_load_dwordx4 v5, s[12:15], s25 offen lds
    v_mfma_f32_32x32x16_bf16 v[96:111], v[136:139], v[132:135], v[96:111]
    s_add_u32 m0, s24, 9216
    s_add_u32 s25, s27, 7168
    buffer_load_dwordx4 v5, s[12:15], s25 offen lds
    s_add_u32 s33, s33, 1
    s_cmp_eq_u32 s33, 28
    s_cselect_b32 s33, 0, s33
    v_add_u32 v13, 16384, v12
    v_add_u32 v10, 16384, v15
    v_add_u32 v11, 16384, v16
    v_mfma_f32_32x32x16_bf16 v[112:127], v[140:143], v[132:135], v[112:127]
    ds_read_b128 v[32:35], v13 offset:0
    ds_read_b128 v[36:39], v13 offset:4096
    ds_read_b64_tr_b16 v[40:41], v10 offset:0
    ds_read_b64_tr_b16 v[42:43], v10 offset:512
    ds_read_b64_tr_b16 v[44:45], v11 offset:0
    ds_read_b64_tr_b16 v[46:47], v11 offset:512
    s_waitcnt vmcnt(12)
    s_waitcnt lgkmcnt(0)
    s_barrier
    v_mfma_f32_32x32x16_bf16 v[64:79], v[40:43], v[32:35], v[64:79]
    s_lshl_b32 s26, s32, 7
    s_add_u32 m0, s24, 16384
    s_add_u32 s25, s26, 0
    buffer_load_dwordx4 v3, s[8:11], s25 offen lds
    s_add_u32 m0, s24, 17408
    s_add_u32 s25, s26, 28672
    buffer_load_dwordx4 v4, s[8:11], s25 offen lds
    s_add_u32 s32, s32, 1
    v_mfma_f32_32x32x16_bf16 v[80:95], v[44:47], v[32:35], v[80:95]
    s_cmp_eq_u32 s32, 28
    s_cselect_b32 s32, 0, s32
    s_mul_i32 s27, s33, 57344
    s_add_u32 m0, s24, 24576
    s_add_u32 s25, s27, 0
    buffer_load_dwordx4 v5, s[12:15], s25 offen lds
    s_add_u32 m0, s24, 25600
    s_add_u32 s25, s27, 7168
    v_mfma_f32_32x32x16_bf16 v[96:111], v[40:43], v[36:39], v[96:111]
    buffer_load_dwordx4 v5, s[12:15], s25 offen lds
    s_add_u32 s33, s33, 1
    s_cmp_eq_u32 s33, 28
    s_cselect_b32 s33, 0, s33
    v_add_u32 v13, 32768, v12
    v_add_u32 v10, 32768, v15
    v_add_u32 v11, 32768, v16
    ds_read_b128 v[128:131], v13 offset:0
    v_mfma_f32_32x32x16_bf16 v[112:127], v[44:47], v[36:39], v[112:127]
    ds_read_b128 v[132:135], v13 offset:4096
    ds_read_b64_tr_b16 v[136:137], v10 offset:0
    ds_read_b64_tr_b16 v[138:139], v10 offset:512
    ds_read_b64_tr_b16 v[140:141], v11 offset:0
    ds_read_b64_tr_b16 v[142:143], v11 offset:512
    s_waitcnt vmcnt(12)
    s_waitcnt lgkmcnt(0)
    s_barrier
    v_mfma_f32_32x32x16_bf16 v[64:79], v[136:139], v[128:131], v[64:79]
    s_lshr_b32 s26, s32, 1
    s_bitcmp1_b32 s36, s26
    s_cbranch_scc0 L_g2_slow_26
L_g2_back_27:
    s_lshl_b32 s26, s32, 7
    s_add_u32 m0, s24, 32768
    s_add_u32 s25, s26, 0
    buffer_load_dwordx4 v3, s[8:11], s25 offen lds
    s_add_u32 m0, s24, 33792
    v_mfma_f32_32x32x16_bf16 v[80:95], v[140:143], v[128:131], v[80:95]
    s_add_u32 s25, s26, 28672
    buffer_load_dwordx4 v4, s[8:11], s25 offen lds
    s_add_u32 s32, s32, 1
    s_cmp_eq_u32 s32, 28
    s_cselect_b32 s32, 0, s32
    s_mul_i32 s27, s33, 57344
    s_add_u32 m0, s24, 40960
    s_add_u32 s25, s27, 0
    buffer_load_dwordx4 v5, s[12:15], s25 offen lds
    v_mfma_f32_32x32x16_bf16 v[96:111], v[136:139], v[132:135], v[96:111]
    s_add_u32 m0, s24, 41984
    s_add_u32 s25, s27, 7168
    buffer_load_dwordx4 v5, s[12:15], s25 offen lds
    s_add_u32 s33, s33, 1
    s_cmp_eq_u32 s33, 28
    s_cselect_b32 s33, 0, s33
    v_add_u32 v13, 49152, v12
    v_add_u32 v10, 49152, v15
    v_add_u32 v11, 49152, v16
    v_mfma_f32_32x32x16_bf16 v[112:127], v[140:143], v[132:135], v[112:127]
    ds_read_b128 v[32:35], v13 offset:0
    ds_read_b128 v[36:39], v13 offset:4096
    ds_read_b64_tr_b16 v[40:41], v10 offset:0
    ds_read_b64_tr_b16 v[42:43], v10 offset:512
    ds_read_b64_tr_b16 v[44:45], v11 offset:0
    ds_read_b64_tr_b16 v[46:47], v11 offset:512
    s_waitcnt vmcnt(12)
    s_waitcnt lgkmcnt(0)
    s_barrier
    v_mfma_f32_32x32x16_bf16 v[64:79], v[40:43], v[32:35], v[64:79]
    s_lshl_b32 s26, s32, 7
    s_add_u32 m0, s24, 49152
    s_add_u32 s25, s26, 0
    buffer_load_dwordx4 v3, s[8:11], s25 offen lds
    s_add_u32 m0, s24, 50176
    s_add_u32 s25, s26, 28672
    buffer_load_dwordx4 v4, s[8:11], s25 offen lds
    s_add_u32 s32, s32, 1
    v_mfma_f32_32x32x16_bf16 v[80:95], v[44:47], v[32:35], v[80:95]
    s_cmp_eq_u32 s32, 28
    s_cselect_b32 s32, 0, s32
    s_mul_i32 s27, s33, 57344
    s_add_u32 m0, s24, 57344
    s_add_u32 s25, s27, 0
    buffer_load_dwordx4 v5, s[12:15], s25 offen lds
    s_add_u32 m0, s24, 58368
    s_add_u32 s25, s27, 7168
    v_mfma_f32_32x32x16_bf16 v[96:111], v[40:43], v[36:39], v[96:111]
    buffer_load_dwordx4 v5, s[12:15], s25 offen lds
    s_add_u32 s33, s33, 1
    s_cmp_eq_u32 s33, 28
    s_cselect_b32 s33, 0, s33
    v_add_u32 v13, 65536, v12
    v_add_u32 v10, 65536, v15
    v_add_u32 v11, 65536, v16
    ds_read_b128 v[128:131], v13 offset:0
    v_mfma_f32_32x32x16_bf16 v[112:127], v[44:47], v[36:39], v[112:127]
    ds_read_b128 v[132:135], v13 offset:4096
    ds_read_b64_tr_b16 v[136:137], v10 offset:0
    ds_read_b64_tr_b16 v[138:139], v10 offset:512
    ds_read_b64_tr_b16 v[140:141], v11 offset:0
    ds_read_b64_tr_b16 v[142:143], v11 offset:512
    s_waitcnt vmcnt(12)
    s_waitcnt lgkmcnt(0)
    s_barrier
    v_mfma_f32_32x32x16_bf16 v[64:79], v[136:139], v[128:131], v[64:79]
    s_lshr_b32 s26, s32, 1
    s_bitcmp1_b32 s36, s26
    s_cbranch_scc0 L_g2_slow_28
L_g2_back_29:
    s_lshl_b32 s26, s32, 7
    s_add_u32 m0, s24, 65536
    s_add_u32 s25, s26, 0
    buffer_load_dwordx4 v3, s[8:11], s25 offen lds
    s_add_u32 m0, s24, 66560
    v_mfma_f32_32x32x16_bf16 v[80:95], v[140:143], v[128:131], v[80:95]
    s_add_u32 s25, s26, 28672
    buffer_load_dwordx4 v4, s[8:11], s25 offen lds
    s_add_u32 s32, s32, 1
    s_cmp_eq_u32 s32, 28
    s_cselect_b32 s32, 0, s32
    s_mul_i32 s27, s33, 57344
    s_add_u32 m0, s24, 73728
    s_add_u32 s25, s27, 0
    buffer_load_dwordx4 v5, s[12:15], s25 offen lds
    v_mfma_f32_32x32x16_bf16 v[96:111], v[136:139], v[132:135], v[96:111]
    s_add_u32 m0, s24, 74752
    s_add_u32 s25, s27, 7168
    buffer_load_dwordx4 v5, s[12:15], s25 offen lds
    s_add_u32 s33, s33, 1
    s_cmp_eq_u32 s33, 28
    s_cselect_b32 s33, 0, s33
    v_add_u32 v13, 0, v12
    v_add_u32 v10, 0, v15
    v_add_u32 v11, 0, v16
    v_mfma_f32_32x32x16_bf16 v[112:127], v[140:143], v[132:135], v[112:127]
    ds_read_b128 v[32:35], v13 offset:0
    ds_read_b128 v[36:39], v13 offset:4096
    ds_read_b64_tr_b16 v[40:41], v10 offset:0
    ds_read_b64_tr_b16 v[42:43], v10 offset:512
    ds_read_b64_tr_b16 v[44:45], v11 offset:0
    ds_read_b64_tr_b16 v[46:47], v11 offset:512
    s_waitcnt vmcnt(12)
    s_waitcnt lgkmcnt(0)
    s_barrier
    v_mfma_f32_32x32x16_bf16 v[64:79], v[40:43], v[32:35], v[64:79]
    s_lshl_b32 s26, s32, 7
    s_add_u32 m0, s24, 0
    s_add_u32 s25, s26, 0
    buffer_load_dwordx4 v3, s[8:11], s25 offen lds
    s_add_u32 m0, s24, 1024
    s_add_u32 s25, s26, 28672
    buffer_load_dwordx4 v4, s[8:11], s25 offen lds
    s_add_u32 s32, s32, 1
    v_mfma_f32_32x32x16_bf16 v[80:95], v[44:47], v[32:35], v[80:95]
    s_cmp_eq_u32 s32, 28
    s_cselect_b32 s32, 0, s32
    s_mul_i32 s27, s33, 57344
    s_add_u32 m0, s24, 8192
    s_add_u32 s25, s27, 0
    buffer_load_dwordx4 v5, s[12:15], s25 offen lds
    s_add_u32 m0, s24, 9216
    s_add_u32 s25, s27, 7168
    v_mfma_f32_32x32x16_bf16 v[96:111], v[40:43], v[36:39], v[96:111]
    buffer_load_dwordx4 v5, s[12:15], s25 offen lds
    s_add_u32 s33, s33, 1
    s_cmp_eq_u32 s33, 28
    s_cselect_b32 s33, 0, s33
    v_add_u32 v13, 16384, v12
    v_add_u32 v10, 16384, v15
    v_add_u32 v11, 16384, v16
    ds_read_b128 v[128:131], v13 offset:0
    v_mfma_f32_32x32x16_bf16 v[112:127], v[44:47], v[36:39], v[112:127]
    ds_read_b128 v[132:135], v13 offset:4096
    ds_read_b64_tr_b16 v[136:137], v10 offset:0
    ds_read_b64_tr_b16 v[138:139], v10 offset:512
    ds_read_b64_tr_b16 v[140:141], v11 offset:0
    ds_read_b64_tr_b16 v[142:143], v11 offset:512
    s_waitcnt vmcnt(12)
    s_waitcnt lgkmcnt(0)
    s_barrier
    v_mfma_f32_32x32x16_bf16 v[64:79], v[136:139], v[128:131], v[64:79]
    s_lshr_b32 s26, s32, 1
    s_bitcmp1_b32 s36, s26
    s_cbranch_scc0 L_g2_slow_30
L_g2_back_31:
    s_lshl_b32 s26, s32, 7
    s_add_u32 m0, s24, 16384
    s_add_u32 s25, s26, 0
    buffer_load_dwordx4 v3, s[8:11], s25 offen lds
    s_add_u32 m0, s24, 17408
    v_mfma_f32_32x32x16_bf16 v[80:95], v[140:143], v[128:131], v[80:95]
    s_add_u32 s25, s26, 28672
    buffer_load_dwordx4 v4, s[8:11], s25 offen lds
    s_add_u32 s32, s32, 1
    s_cmp_eq_u32 s32, 28
    s_cselect_b32 s32, 0, s32
    s_mul_i32 s27, s33, 57344
    s_add_u32 m0, s24, 24576
    s_add_u32 s25, s27, 0
    buffer_load_dwordx4 v5, s[12:15], s25 offen lds
    v_mfma_f32_32x32x16_bf16 v[96:111], v[136:139], v[132:135], v[96:111]
    s_add_u32 m0, s24, 25600
    s_add_u32 s25, s27, 7168
    buffer_load_dwordx4 v5, s[12:15], s25 offen lds
    s_add_u32 s33, s33, 1
    s_cmp_eq_u32 s33, 28
    s_cselect_b32 s33, 0, s33
    v_add_u32 v13, 32768, v12
    v_add_u32 v10, 32768, v15
    v_add_u32 v11, 32768, v16
    v_mfma_f32_32x32x16_bf16 v[112:127], v[140:143], v[132:135], v[112:127]
    ds_read_b128 v[32:35], v13 offset:0
    ds_read_b128 v[36:39], v13 offset:4096
    ds_read_b64_tr_b16 v[40:41], v10 offset:0
    ds_read_b64_tr_b16 v[42:43], v10 offset:512
    ds_read_b64_tr_b16 v[44:45], v11 offset:0
    ds_read_b64_tr_b16 v[46:47], v11 offset:512
    s_waitcnt vmcnt(12)
    s_waitcnt lgkmcnt(0)
    s_barrier
    v_mfma_f32_32x32x16_bf16 v[64:79], v[40:43], v[32:35], v[64:79]
    s_lshl_b32 s26, s32, 7
    s_add_u32 m0, s24, 32768
    s_add_u32 s25, s26, 0
    buffer_load_dwordx4 v3, s[8:11], s25 offen lds
    s_add_u32 m0, s24, 33792
    s_add_u32 s25, s26, 28672
    buffer_load_dwordx4 v4, s[8:11], s25 offen lds
    s_add_u32 s32, s32, 1
    v_mfma_f32_32x32x16_bf16 v[80:95], v[44:47], v[32:35], v[80:95]
    s_cmp_eq_u32 s32, 28
    s_cselect_b32 s32, 0, s32
    s_mul_i32 s27, s33, 57344
    s_add_u32 m0, s24, 40960
    s_add_u32 s25, s27, 0
    buffer_load_dwordx4 v5, s[12:15], s25 offen lds
    s_add_u32 m0, s24, 41984
    s_add_u32 s25, s27, 7168
    v_mfma_f32_32x32x16_bf16 v[96:111], v[40:43], v[36:39], v[96:111]
    buffer_load_dwordx4 v5, s[12:15], s25 offen lds
    s_add_u32 s33, s33, 1
    s_cmp_eq_u32 s33, 28
    s_cselect_b32 s33, 0, s33
    v_add_u32 v13, 49152, v12
    v_add_u32 v10, 49152, v15
    v_add_u32 v11, 49152, v16
    ds_read_b128 v[128:131], v13 offset:0
    v_mfma_f32_32x32x16_bf16 v[112:127], v[44:47], v[36:39], v[112:127]
    ds_read_b128 v[132:135], v13 offset:4096
    ds_read_b64_tr_b16 v[136:137], v10 offset:0
    ds_read_b64_tr_b16 v[138:139], v10 offset:512
    ds_read_b64_tr_b16 v[140:141], v11 offset:0
    ds_read_b64_tr_b16 v[142:143], v11 offset:512
    s_waitcnt vmcnt(12)
    s_waitcnt lgkmcnt(0)
    s_barrier
    v_mfma_f32_32x32x16_bf16 v[64:79], v[136:139], v[128:131], v[64:79]
    s_lshr_b32 s26, s32, 1
    s_bitcmp1_b32 s36, s26
    s_cbranch_scc0 L_g2_slow_32
L_g2_back_33:
    s_lshl_b32 s26, s32, 7
    s_add_u32 m0, s24, 49152
    s_add_u32 s25, s26, 0
    buffer_load_dwordx4 v3, s[8:11], s25 offen lds
    s_add_u32 m0, s24, 50176
    v_mfma_f32_32x32x16_bf16 v[80:95], v[140:143], v[128:131], v[80:95]
    s_add_u32 s25, s26, 28672
    buffer_load_dwordx4 v4, s[8:11], s25 offen lds
    s_add_u32 s32, s32, 1
    s_cmp_eq_u32 s32, 28
    s_cselect_b32 s32, 0, s32
    s_mul_i32 s27, s33, 57344
    s_add_u32 m0, s24, 57344
    s_add_u32 s25, s27, 0
    buffer_load_dwordx4 v5, s[12:15], s25 offen lds
    v_mfma_f32_32x32x16_bf16 v[96:111], v[136:139], v[132:135], v[96:111]
    s_add_u32 m0, s24, 58368
    s_add_u32 s25, s27, 7168
    buffer_load_dwordx4 v5, s[12:15], s25 offen lds
    s_add_u32 s33, s33, 1
    s_cmp_eq_u32 s33, 28
    s_cselect_b32 s33, 0, s33
    v_add_u32 v13, 65536, v12
    v_add_u32 v10, 65536, v15
    v_add_u32 v11, 65536, v16
    v_mfma_f32_32x32x16_bf16 v[112:127], v[140:143], v[132:135], v[112:127]
    ds_read_b128 v[32:35], v13 offset:0
    ds_read_b128 v[36:39], v13 offset:4096
    ds_read_b64_tr_b16 v[40:41], v10 offset:0
    ds_read_b64_tr_b16 v[42:43], v10 offset:512
    ds_read_b64_tr_b16 v[44:45], v11 offset:0
    ds_read_b64_tr_b16 v[46:47], v11 offset:512
    s_waitcnt vmcnt(12)
    s_waitcnt lgkmcnt(0)
    s_barrier
    v_mfma_f32_32x32x16_bf16 v[64:79], v[40:43], v[32:35], v[64:79]
    s_lshl_b32 s26, s32, 7
    s_add_u32 m0, s24, 65536
    s_add_u32 s25, s26, 0
    buffer_load_dwordx4 v3, s[8:11], s25 offen lds
    s_add_u32 m0, s24, 66560
    s_add_u32 s25, s26, 28672
    buffer_load_dwordx4 v4, s[8:11], s25 offen lds
    s_add_u32 s32, s32, 1
    v_mfma_f32_32x32x16_bf16 v[80:95], v[44:47], v[32:35], v[80:95]
    s_cmp_eq_u32 s32, 28
    s_cselect_b32 s32, 0, s32
    s_mul_i32 s27, s33, 57344
    s_add_u32 m0, s24, 73728
    s_add_u32 s25, s27, 0
    buffer_load_dwordx4 v5, s[12:15], s25 offen lds
    s_add_u32 m0, s24, 74752
    s_add_u32 s25, s27, 7168
    v_mfma_f32_32x32x16_bf16 v[96:111], v[40:43], v[36:39], v[96:111]
    buffer_load_dwordx4 v5, s[12:15], s25 offen lds
    s_add_u32 s33, s33, 1
    s_cmp_eq_u32 s33, 28
    s_cselect_b32 s33, 0, s33
    v_add_u32 v13, 0, v12
    v_add_u32 v10, 0, v15
    v_add_u32 v11, 0, v16
    ds_read_b128 v[128:131], v13 offset:0
    v_mfma_f32_32x32x16_bf16 v[112:127], v[44:47], v[36:39], v[112:127]
    ds_read_b128 v[132:135], v13 offset:4096
    ds_read_b64_tr_b16 v[136:137], v10 offset:0
    ds_read_b64_tr_b16 v[138:139], v10 offset:512
    ds_read_b64_tr_b16 v[140:141], v11 offset:0
    ds_read_b64_tr_b16 v[142:143], v11 offset:512
    s_waitcnt vmcnt(12)
    s_waitcnt lgkmcnt(0)
    s_barrier
    v_mfma_f32_32x32x16_bf16 v[64:79], v[136:139], v[128:131], v[64:79]
    s_lshr_b32 s26, s32, 1
    s_bitcmp1_b32 s36, s26
    s_cbranch_scc0 L_g2_slow_34
L_g2_back_35:
    s_lshl_b32 s26, s32, 7
    s_add_u32 m0, s24, 0
    s_add_u32 s25, s26, 0
    buffer_load_dwordx4 v3, s[8:11], s25 offen lds
    s_add_u32 m0, s24, 1024
    v_mfma_f32_32x32x16_bf16 v[80:95], v[140:143], v[128:131], v[80:95]
    s_add_u32 s25, s26, 28672
    buffer_load_dwordx4 v4, s[8:11], s25 offen lds
    s_add_u32 s32, s32, 1
    s_cmp_eq_u32 s32, 28
    s_cselect_b32 s32, 0, s32
    s_mul_i32 s27, s33, 57344
    s_add_u32 m0, s24, 8192
    s_add_u32 s25, s27, 0
    buffer_load_dwordx4 v5, s[12:15], s25 offen lds
    v_mfma_f32_32x32x16_bf16 v[96:111], v[136:139], v[132:135], v[96:111]
    s_add_u32 m0, s24, 9216
    s_add_u32 s25, s27, 7168
    buffer_load_dwordx4 v5, s[12:15], s25 offen lds
    s_add_u32 s33, s33, 1
    s_cmp_eq_u32 s33, 28
    s_cselect_b32 s33, 0, s33
    v_add_u32 v13, 16384, v12
    v_add_u32 v10, 16384, v15
    v_add_u32 v11, 16384, v16
    v_mfma_f32_32x32x16_bf16 v[112:127], v[140:143], v[132:135], v[112:127]
    ds_read_b128 v[32:35], v13 offset:0
    ds_read_b128 v[36:39], v13 offset:4096
    ds_read_b64_tr_b16 v[40:41], v10 offset:0
    ds_read_b64_tr_b16 v[42:43], v10 offset:512
    ds_read_b64_tr_b16 v[44:45], v11 offset:0
    ds_read_b64_tr_b16 v[46:47], v11 offset:512
    s_waitcnt vmcnt(12)
    s_waitcnt lgkmcnt(0)
    s_barrier
    v_mfma_f32_32x32x16_bf16 v[64:79], v[40:43], v[32:35], v[64:79]
    s_lshl_b32 s26, s32, 7
    s_add_u32 m0, s24, 16384
    s_add_u32 s25, s26, 0
    buffer_load_dwordx4 v3, s[8:11], s25 offen lds
    s_add_u32 m0, s24, 17408
    s_add_u32 s25, s26, 28672
    buffer_load_dwordx4 v4, s[8:11], s25 offen lds
    s_add_u32 s32, s32, 1
    v_mfma_f32_32x32x16_bf16 v[80:95], v[44:47], v[32:35], v[80:95]
    s_cmp_eq_u32 s32, 28
    s_cselect_b32 s32, 0, s32
    s_mul_i32 s27, s33, 57344
    s_add_u32 m0, s24, 24576
    s_add_u32 s25, s27, 0
    buffer_load_dwordx4 v5, s[12:15], s25 offen lds
    s_add_u32 m0, s24, 25600
    s_add_u32 s25, s27, 7168
    v_mfma_f32_32x32x16_bf16 v[96:111], v[40:43], v[36:39], v[96:111]
    buffer_load_dwordx4 v5, s[12:15], s25 offen lds
    s_add_u32 s33, s33, 1
    s_cmp_eq_u32 s33, 28
    s_cselect_b32 s33, 0, s33
    v_add_u32 v13, 32768, v12
    v_add_u32 v10, 32768, v15
    v_add_u32 v11, 32768, v16
    ds_read_b128 v[128:131], v13 offset:0
    v_mfma_f32_32x32x16_bf16 v[112:127], v[44:47], v[36:39], v[112:127]
    ds_read_b128 v[132:135], v13 offset:4096
    ds_read_b64_tr_b16 v[136:137], v10 offset:0
    ds_read_b64_tr_b16 v[138:139], v10 offset:512
    ds_read_b64_tr_b16 v[140:141], v11 offset:0
    ds_read_b64_tr_b16 v[142:143], v11 offset:512
    s_waitcnt vmcnt(12)
    s_waitcnt lgkmcnt(0)
    s_barrier
    v_mfma_f32_32x32x16_bf16 v[64:79], v[136:139], v[128:131], v[64:79]
    s_lshr_b32 s26, s32, 1
    s_bitcmp1_b32 s36, s26
    s_cbranch_scc0 L_g2_slow_36
L_g2_back_37:
    s_lshl_b32 s26, s32, 7
    s_add_u32 m0, s24, 32768
    s_add_u32 s25, s26, 0
    buffer_load_dwordx4 v3, s[8:11], s25 offen lds
    s_add_u32 m0, s24, 33792
    v_mfma_f32_32x32x16_bf16 v[80:95], v[140:143], v[128:131], v[80:95]
    s_add_u32 s25, s26, 28672
    buffer_load_dwordx4 v4, s[8:11], s25 offen lds
    s_add_u32 s32, s32, 1
    s_cmp_eq_u32 s32, 28
    s_cselect_b32 s32, 0, s32
    s_mul_i32 s27, s33, 57344
    s_add_u32 m0, s24, 40960
    s_add_u32 s25, s27, 0
    buffer_load_dwordx4 v5, s[12:15], s25 offen lds
    v_mfma_f32_32x32x16_bf16 v[96:111], v[136:139], v[132:135], v[96:111]
    s_add_u32 m0, s24, 41984
    s_add_u32 s25, s27, 7168
    buffer_load_dwordx4 v5, s[12:15], s25 offen lds
    s_add_u32 s33, s33, 1
    s_cmp_eq_u32 s33, 28
    s_cselect_b32 s33, 0, s33
    v_add_u32 v13, 49152, v12
    v_add_u32 v10, 49152, v15
    v_add_u32 v11, 49152, v16
    v_mfma_f32_32x32x16_bf16 v[112:127], v[140:143], v[132:135], v[112:127]
    ds_read_b128 v[32:35], v13 offset:0
    ds_read_b128 v[36:39], v13 offset:4096
    ds_read_b64_tr_b16 v[40:41], v10 offset:0
    ds_read_b64_tr_b16 v[42:43], v10 offset:512
    ds_read_b64_tr_b16 v[44:45], v11 offset:0
    ds_read_b64_tr_b16 v[46:47], v11 offset:512
    s_waitcnt vmcnt(12)
    s_waitcnt lgkmcnt(0)
    s_barrier
    v_mfma_f32_32x32x16_bf16 v[64:79], v[40:43], v[32:35], v[64:79]
    s_lshl_b32 s26, s32, 7
    s_add_u32 m0, s24, 49152
    s_add_u32 s25, s26, 0
    buffer_load_dwordx4 v3, s[8:11], s25 offen lds
    s_add_u32 m0, s24, 50176
    s_add_u32 s25, s26, 28672
    buffer_load_dwordx4 v4, s[8:11], s25 offen lds
    s_add_u32 s32, s32, 1
    v_mfma_f32_32x32x16_bf16 v[80:95], v[44:47], v[32:35], v[80:95]
    s_cmp_eq_u32 s32, 28
    s_cselect_b32 s32, 0, s32
    s_mul_i32 s27, s33, 57344
    s_add_u32 m0, s24, 57344
    s_add_u32 s25, s27, 0
    buffer_load_dwordx4 v5, s[12:15], s25 offen lds
    s_add_u32 m0, s24, 58368
    s_add_u32 s25, s27, 7168
    v_mfma_f32_32x32x16_bf16 v[96:111], v[40:43], v[36:39], v[96:111]
    buffer_load_dwordx4 v5, s[12:15], s25 offen lds
    s_add_u32 s33, s33, 1
    s_cmp_eq_u32 s33, 28
    s_cselect_b32 s33, 0, s33
    v_add_u32 v13, 65536, v12
    v_add_u32 v10, 65536, v15
    v_add_u32 v11, 65536, v16
    ds_read_b128 v[128:131], v13 offset:0
    v_mfma_f32_32x32x16_bf16 v[112:127], v[44:47], v[36:39], v[112:127]
    ds_read_b128 v[132:135], v13 offset:4096
    ds_read_b64_tr_b16 v[136:137], v10 offset:0
    ds_read_b64_tr_b16 v[138:139], v10 offset:512
    ds_read_b64_tr_b16 v[140:141], v11 offset:0
    ds_read_b64_tr_b16 v[142:143], v11 offset:512
    s_waitcnt vmcnt(12)
    s_waitcnt lgkmcnt(0)
    s_barrier
    v_mfma_f32_32x32x16_bf16 v[64:79], v[136:139], v[128:131], v[64:79]
    s_lshr_b32 s26, s32, 1
    s_bitcmp1_b32 s36, s26
    s_cbranch_scc0 L_g2_slow_38
L_g2_back_39:
    s_lshl_b32 s26, s32, 7
    s_add_u32 m0, s24, 65536
    s_add_u32 s25, s26, 0
    buffer_load_dwordx4 v3, s[8:11], s25 offen lds
    s_add_u32 m0, s24, 66560
    v_mfma_f32_32x32x16_bf16 v[80:95], v[140:143], v[128:131], v[80:95]
    s_add_u32 s25, s26, 28672
    buffer_load_dwordx4 v4, s[8:11], s25 offen lds
    s_add_u32 s32, s32, 1
    s_cmp_eq_u32 s32, 28
    s_cselect_b32 s32, 0, s32
    s_mul_i32 s27, s33, 57344
    s_add_u32 m0, s24, 73728
    s_add_u32 s25, s27, 0
    buffer_load_dwordx4 v5, s[12:15], s25 offen lds
    v_mfma_f32_32x32x16_bf16 v[96:111], v[136:139], v[132:135], v[96:111]
    s_add_u32 m0, s24, 74752
    s_add_u32 s25, s27, 7168
    buffer_load_dwordx4 v5, s[12:15], s25 offen lds
    s_add_u32 s33, s33, 1
    s_cmp_eq_u32 s33, 28
    s_cselect_b32 s33, 0, s33
    v_add_u32 v13, 0, v12
    v_add_u32 v10, 0, v15
    v_add_u32 v11, 0, v16
    v_mfma_f32_32x32x16_bf16 v[112:127], v[140:143], v[132:135], v[112:127]
    ds_read_b128 v[32:35], v13 offset:0
    ds_read_b128 v[36:39], v13 offset:4096
    ds_read_b64_tr_b16 v[40:41], v10 offset:0
    ds_read_b64_tr_b16 v[42:43], v10 offset:512
    ds_read_b64_tr_b16 v[44:45], v11 offset:0
    ds_read_b64_tr_b16 v[46:47], v11 offset:512
    s_waitcnt vmcnt(12)
    s_waitcnt lgkmcnt(0)
    s_barrier
    v_mfma_f32_32x32x16_bf16 v[64:79], v[40:43], v[32:35], v[64:79]
    s_lshl_b32 s26, s32, 7
    s_add_u32 m0, s24, 0
    s_add_u32 s25, s26, 0
    buffer_load_dwordx4 v3, s[8:11], s25 offen lds
    s_add_u32 m0, s24, 1024
    s_add_u32 s25, s26, 28672
    buffer_load_dwordx4 v4, s[8:11], s25 offen lds
    s_add_u32 s32, s32, 1
    v_mfma_f32_32x32x16_bf16 v[80:95], v[44:47], v[32:35], v[80:95]
    s_cmp_eq_u32 s32, 28
    s_cselect_b32 s32, 0, s32
    s_mul_i32 s27, s33, 57344
    s_add_u32 m0, s24, 8192
    s_add_u32 s25, s27, 0
    buffer_load_dwordx4 v5, s[12:15], s25 offen lds
    s_add_u32 m0, s24, 9216
    s_add_u32 s25, s27, 7168
    v_mfma_f32_32x32x16_bf16 v[96:111], v[40:43], v[36:39], v[96:111]
    buffer_load_dwordx4 v5, s[12:15], s25 offen lds
    s_add_u32 s33, s33, 1
    s_cmp_eq_u32 s33, 28
    s_cselect_b32 s33, 0, s33
    v_add_u32 v13, 16384, v12
    v_add_u32 v10, 16384, v15
    v_add_u32 v11, 16384, v16
    ds_read_b128 v[128:131], v13 offset:0
    v_mfma_f32_32x32x16_bf16 v[112:127], v[44:47], v[36:39], v[112:127]
    ds_read_b128 v[132:135], v13 offset:4096
    ds_read_b64_tr_b16 v[136:137], v10 offset:0
    ds_read_b64_tr_b16 v[138:139], v10 offset:512
    ds_read_b64_tr_b16 v[140:141], v11 offset:0
    ds_read_b64_tr_b16 v[142:143], v11 offset:512
    s_waitcnt vmcnt(12)
    s_waitcnt lgkmcnt(0)
    s_barrier
    v_mfma_f32_32x32x16_bf16 v[64:79], v[136:139], v[128:131], v[64:79]
    s_lshr_b32 s26, s32, 1
    s_bitcmp1_b32 s36, s26
    s_cbranch_scc0 L_g2_slow_40
L_g2_back_41:
    s_lshl_b32 s26, s32, 7
    s_add_u32 m0, s24, 16384
    s_add_u32 s25, s26, 0
    buffer_load_dwordx4 v3, s[8:11], s25 offen lds
    s_add_u32 m0, s24, 17408
    v_mfma_f32_32x32x16_bf16 v[80:95], v[140:143], v[128:131], v[80:95]
    s_add_u32 s25, s26, 28672
    buffer_load_dwordx4 v4, s[8:11], s25 offen lds
    s_add_u32 s32, s32, 1
    s_cmp_eq_u32 s32, 28
    s_cselect_b32 s32, 0, s32
    s_mul_i32 s27, s33, 57344
    s_add_u32 m0, s24, 24576
    s_add_u32 s25, s27, 0
    buffer_load_dwordx4 v5, s[12:15], s25 offen lds
    v_mfma_f32_32x32x16_bf16 v[96:111], v[136:139], v[132:135], v[96:111]
    s_add_u32 m0, s24, 25600
    s_add_u32 s25, s27, 7168
    buffer_load_dwordx4 v5, s[12:15], s25 offen lds
    s_add_u32 s33, s33, 1
    s_cmp_eq_u32 s33, 28
    s_cselect_b32 s33, 0, s33
    v_add_u32 v13, 32768, v12
    v_add_u32 v10, 32768, v15
    v_add_u32 v11, 32768, v16
    v_mfma_f32_32x32x16_bf16 v[112:127], v[140:143], v[132:135], v[112:127]
    ds_read_b128 v[32:35], v13 offset:0
    ds_read_b128 v[36:39], v13 offset:4096
    ds_read_b64_tr_b16 v[40:41], v10 offset:0
    ds_read_b64_tr_b16 v[42:43], v10 offset:512
    ds_read_b64_tr_b16 v[44:45], v11 offset:0
    ds_read_b64_tr_b16 v[46:47], v11 offset:512
    s_waitcnt vmcnt(12)
    s_waitcnt lgkmcnt(0)
    s_barrier
    v_mfma_f32_32x32x16_bf16 v[64:79], v[40:43], v[32:35], v[64:79]
    s_lshl_b32 s26, s32, 7
    s_add_u32 m0, s24, 32768
    s_add_u32 s25, s26, 0
    buffer_load_dwordx4 v3, s[8:11], s25 offen lds
    s_add_u32 m0, s24, 33792
    s_add_u32 s25, s26, 28672
    buffer_load_dwordx4 v4, s[8:11], s25 offen lds
    s_add_u32 s32, s32, 1
    v_mfma_f32_32x32x16_bf16 v[80:95], v[44:47], v[32:35], v[80:95]
    s_cmp_eq_u32 s32, 28
    s_cselect_b32 s32, 0, s32
    s_mul_i32 s27, s33, 57344
    s_add_u32 m0, s24, 40960
    s_add_u32 s25, s27, 0
    buffer_load_dwordx4 v5, s[12:15], s25 offen lds
    s_add_u32 m0, s24, 41984
    s_add_u32 s25, s27, 7168
    v_mfma_f32_32x32x16_bf16 v[96:111], v[40:43], v[36:39], v[96:111]
    buffer_load_dwordx4 v5, s[12:15], s25 offen lds
    s_add_u32 s33, s33, 1
    s_cmp_eq_u32 s33, 28
    s_cselect_b32 s33, 0, s33
    v_add_u32 v13, 49152, v12
    v_add_u32 v10, 49152, v15
    v_add_u32 v11, 49152, v16
    ds_read_b128 v[128:131], v13 offset:0
    v_mfma_f32_32x32x16_bf16 v[112:127], v[44:47], v[36:39], v[112:127]
    ds_read_b128 v[132:135], v13 offset:4096
    ds_read_b64_tr_b16 v[136:137], v10 offset:0
    ds_read_b64_tr_b16 v[138:139], v10 offset:512
    ds_read_b64_tr_b16 v[140:141], v11 offset:0
    ds_read_b64_tr_b16 v[142:143], v11 offset:512
    s_waitcnt vmcnt(12)
    s_waitcnt lgkmcnt(0)
    s_barrier
    v_mfma_f32_32x32x16_bf16 v[64:79], v[136:139], v[128:131], v[64:79]
    v_add_u32 v13, 65536, v12
    v_add_u32 v10, 65536, v15
    v_add_u32 v11, 65536, v16
    v_mfma_f32_32x32x16_bf16 v[80:95], v[140:143], v[128:131], v[80:95]
    ds_read_b128 v[32:35], v13 offset:0
    ds_read_b128 v[36:39], v13 offset:4096
    ds_read_b64_tr_b16 v[40:41], v10 offset:0
    v_mfma_f32_32x32x16_bf16 v[96:111], v[136:139], v[132:135], v[96:111]
    ds_read_b64_tr_b16 v[42:43], v10 offset:512
    ds_read_b64_tr_b16 v[44:45], v11 offset:0
    ds_read_b64_tr_b16 v[46:47], v11 offset:512
    v_mfma_f32_32x32x16_bf16 v[112:127], v[140:143], v[132:135], v[112:127]
    s_lshl_b32 s30, s21, 8
    s_add_u32 s30, s30, 4096
    v_mov_b32 v18, s30
    buffer_load_dword v19, v18, s[52:55], 0 offen sc1
    s_waitcnt vmcnt(9)
    s_waitcnt lgkmcnt(0)
    s_barrier
    v_mfma_f32_32x32x16_bf16 v[64:79], v[40:43], v[32:35], v[64:79]
    v_add_u32 v13, 0, v12
    v_add_u32 v10, 0, v15
    v_add_u32 v11, 0, v16
    v_mfma_f32_32x32x16_bf16 v[80:95], v[44:47], v[32:35], v[80:95]
    ds_read_b128 v[128:131], v13 offset:0
    ds_read_b128 v[132:135], v13 offset:4096
    ds_read_b64_tr_b16 v[136:137], v10 offset:0
    v_mfma_f32_32x32x16_bf16 v[96:111], v[40:43], v[36:39], v[96:111]
    ds_read_b64_tr_b16 v[138:139], v10 offset:512
    ds_read_b64_tr_b16 v[140:141], v11 offset:0
    ds_read_b64_tr_b16 v[142:143], v11 offset:512
    v_mfma_f32_32x32x16_bf16 v[112:127], v[44:47], v[36:39], v[112:127]
    s_waitcnt vmcnt(5)
    s_waitcnt lgkmcnt(0)
    s_barrier
    v_mfma_f32_32x32x16_bf16 v[64:79], v[136:139], v[128:131], v[64:79]
    v_add_u32 v13, 16384, v12
    v_add_u32 v10, 16384, v15
    v_add_u32 v11, 16384, v16
    v_mfma_f32_32x32x16_bf16 v[80:95], v[140:143], v[128:131], v[80:95]
    ds_read_b128 v[32:35], v13 offset:0
    ds_read_b128 v[36:39], v13 offset:4096
    ds_read_b64_tr_b16 v[40:41], v10 offset:0
    v_mfma_f32_32x32x16_bf16 v[96:111], v[136:139], v[132:135], v[96:111]
    ds_read_b64_tr_b16 v[42:43], v10 offset:512
    ds_read_b64_tr_b16 v[44:45], v11 offset:0
    ds_read_b64_tr_b16 v[46:47], v11 offset:512
    v_mfma_f32_32x32x16_bf16 v[112:127], v[140:143], v[132:135], v[112:127]
    s_waitcnt vmcnt(1)
    s_waitcnt lgkmcnt(0)
    s_barrier
    v_mfma_f32_32x32x16_bf16 v[64:79], v[40:43], v[32:35], v[64:79]
    v_add_u32 v13, 32768, v12
    v_add_u32 v10, 32768, v15
    v_add_u32 v11, 32768, v16
    v_mfma_f32_32x32x16_bf16 v[80:95], v[44:47], v[32:35], v[80:95]
    ds_read_b128 v[128:131], v13 offset:0
    ds_read_b128 v[132:135], v13 offset:4096
    ds_read_b64_tr_b16 v[136:137], v10 offset:0
    v_mfma_f32_32x32x16_bf16 v[96:111], v[40:43], v[36:39], v[96:111]
    ds_read_b64_tr_b16 v[138:139], v10 offset:512
    ds_read_b64_tr_b16 v[140:141], v11 offset:0
    ds_read_b64_tr_b16 v[142:143], v11 offset:512
    v_mfma_f32_32x32x16_bf16 v[112:127], v[44:47], v[36:39], v[112:127]
    s_waitcnt vmcnt(0)
    s_mov_b32 s38, 0
L_cf_poll_42:
    v_readfirstlane_b32 s23, v19
    s_nop 3
    s_cmp_ge_u32 s23, 32
    s_cbranch_scc1 L_cf_ok_43
    s_add_u32 s38, s38, 1
    s_cmp_ge_u32 s38, 0x80000
    s_cbranch_scc1 L_cf_ok_43
    s_sleep 16
    buffer_load_dword v19, v18, s[52:55], 0 offen sc1
    s_waitcnt vmcnt(0)
    s_branch L_cf_poll_42
L_cf_ok_43:
    s_mov_b32 s25, 0
    buffer_load_ushort v144, v17, s[16:19], s25 offen sc1
    s_mov_b32 s25, 4096
    buffer_load_ushort v145, v17, s[16:19], s25 offen sc1
    s_mov_b32 s25, 8192
    buffer_load_ushort v146, v17, s[16:19], s25 offen sc1
    s_mov_b32 s25, 12288
    buffer_load_ushort v147, v17, s[16:19], s25 offen sc1
    s_mov_b32 s25, 16384
    buffer_load_ushort v148, v17, s[16:19], s25 offen sc1
    s_mov_b32 s25, 20480
    buffer_load_ushort v149, v17, s[16:19], s25 offen sc1
    s_mov_b32 s25, 24576
    buffer_load_ushort v150, v17, s[16:19], s25 offen sc1
    s_mov_b32 s25, 28672
    buffer_load_ushort v151, v17, s[16:19], s25 offen sc1
    s_mov_b32 s25, 32768
    buffer_load_ushort v152, v17, s[16:19], s25 offen sc1
    s_mov_b32 s25, 36864
    buffer_load_ushort v153, v17, s[16:19], s25 offen sc1
    s_mov_b32 s25, 40960
    buffer_load_ushort v154, v17, s[16:19], s25 offen sc1
    s_mov_b32 s25, 45056
    buffer_load_ushort v155, v17, s[16:19], s25 offen sc1
    s_mov_b32 s25, 49152
    buffer_load_ushort v156, v17, s[16:19], s25 offen sc1
    s_mov_b32 s25, 53248
    buffer_load_ushort v157, v17, s[16:19], s25 offen sc1
    s_mov_b32 s25, 57344
    buffer_load_ushort v158, v17, s[16:19], s25 offen sc1
    s_mov_b32 s25, 61440
    buffer_load_ushort v159, v17, s[16:19], s25 offen sc1
    s_waitcnt lgkmcnt(0)
    s_barrier
    v_mfma_f32_32x32x16_bf16 v[64:79], v[136:139], v[128:131], v[64:79]
    v_mfma_f32_32x32x16_bf16 v[80:95], v[140:143], v[128:131], v[80:95]
    v_mfma_f32_32x32x16_bf16 v[96:111], v[136:139], v[132:135], v[96:111]
    v_mfma_f32_32x32x16_bf16 v[112:127], v[140:143], v[132:135], v[112:127]
    s_nop 15
    s_barrier
    v_mul_u32_u24 v20, 17408, v2
    v_mul_u32_u24 v21, 272, v8
    v_add_u32 v20, v20, v21
    v_lshl_add_u32 v20, v9, 4, v20
    ds_write_b128 v20, v[64:67] offset:0
    ds_write_b128 v20, v[68:71] offset:32
    ds_write_b128 v20, v[72:75] offset:64
    ds_write_b128 v20, v[76:79] offset:96
    ds_write_b128 v20, v[80:83] offset:128
    ds_write_b128 v20, v[84:87] offset:160
    ds_write_b128 v20, v[88:91] offset:192
    ds_write_b128 v20, v[92:95] offset:224
    ds_write_b128 v20, v[96:99] offset:8704
    ds_write_b128 v20, v[100:103] offset:8736
    ds_write_b128 v20, v[104:107] offset:8768
    ds_write_b128 v20, v[108:111] offset:8800
    ds_write_b128 v20, v[112:115] offset:8832
    ds_write_b128 v20, v[116:119] offset:8864
    ds_write_b128 v20, v[120:123] offset:8896
    ds_write_b128 v20, v[124:127] offset:8928
    s_waitcnt lgkmcnt(0)
    s_barrier
    v_mul_u32_u24 v20, 272, v1
    v_lshl_add_u32 v20, v2, 6, v20
    ds_read_b128 v[64:67], v20 offset:0
    ds_read_b128 v[68:71], v20 offset:16
    ds_read_b128 v[72:75], v20 offset:32
    ds_read_b128 v[76:79], v20 offset:48
    ds_read_b128 v[80:83], v20 offset:17408
    ds_read_b128 v[84:87], v20 offset:17424
    ds_read_b128 v[88:91], v20 offset:17440
    ds_read_b128 v[92:95], v20 offset:17456
    ds_read_b128 v[96:99], v20 offset:34816
    ds_read_b128 v[100:103], v20 offset:34832
    ds_read_b128 v[104:107], v20 offset:34848
    ds_read_b128 v[108:111], v20 offset:34864
    ds_read_b128 v[112:115], v20 offset:52224
    ds_read_b128 v[116:119], v20 offset:52240
    ds_read_b128 v[120:123], v20 offset:52256
    ds_read_b128 v[124:127], v20 offset:52272
    s_waitcnt lgkmcnt(0)
    v_add_f32 v64, v64, v80
    v_add_f32 v96, v96, v112
    v_add_f32 v64, v64, v96
    v_add_f32 v65, v65, v81
    v_add_f32 v97, v97, v113
    v_add_f32 v65, v65, v97
    v_add_f32 v66, v66, v82
    v_add_f32 v98, v98, v114
    v_add_f32 v66, v66, v98
    v_add_f32 v67, v67, v83
    v_add_f32 v99, v99, v115
    v_add_f32 v67, v67, v99
    v_add_f32 v68, v68, v84
    v_add_f32 v100, v100, v116
    v_add_f32 v68, v68, v100
    v_add_f32 v69, v69, v85
    v_add_f32 v101, v101, v117
    v_add_f32 v69, v69, v101
    v_add_f32 v70, v70, v86
    v_add_f32 v102, v102, v118
    v_add_f32 v70, v70, v102
    v_add_f32 v71, v71, v87
    v_add_f32 v103, v103, v119
    v_add_f32 v71, v71, v103
    v_add_f32 v72, v72, v88
    v_add_f32 v104, v104, v120
    v_add_f32 v72, v72, v104
    v_add_f32 v73, v73, v89
    v_add_f32 v105, v105, v121
    v_add_f32 v73, v73, v105
    v_add_f32 v74, v74, v90
    v_add_f32 v106, v106, v122
    v_add_f32 v74, v74, v106
    v_add_f32 v75, v75, v91
    v_add_f32 v107, v107, v123
    v_add_f32 v75, v75, v107
    v_add_f32 v76, v76, v92
    v_add_f32 v108, v108, v124
    v_add_f32 v76, v76, v108
    v_add_f32 v77, v77, v93
    v_add_f32 v109, v109, v125
    v_add_f32 v77, v77, v109
    v_add_f32 v78, v78, v94
    v_add_f32 v110, v110, v126
    v_add_f32 v78, v78, v110
    v_add_f32 v79, v79, v95
    v_add_f32 v111, v111, v127
    v_add_f32 v79, v79, v111
    v_cvt_pk_bf16_f32 v4, v64, v65
    v_lshlrev_b32 v5, 16, v4
    v_and_b32 v6, 0xffff0000, v4
    v_mul_f32 v7, 0xbfb8aa3b, v5
    v_mul_f32 v10, 0xbfb8aa3b, v6
    v_exp_f32 v7, v7
    v_exp_f32 v10, v10
    s_nop 0
    v_add_f32 v7, 1.0, v7
    v_add_f32 v10, 1.0, v10
    v_rcp_f32 v7, v7
    v_rcp_f32 v10, v10
    s_nop 0
    v_mul_f32 v5, v5, v7
    v_mul_f32 v6, v6, v10
    v_cvt_pk_bf16_f32 v4, v5, v6
    v_lshlrev_b32 v5, 16, v4
    v_and_b32 v6, 0xffff0000, v4
    s_waitcnt vmcnt(0)
    v_lshlrev_b32 v7, 16, v144
    v_lshlrev_b32 v10, 16, v145
    v_mul_f32 v5, v5, v7
    v_mul_f32 v6, v6, v10
    v_cvt_pk_bf16_f32 v4, v5, v6
    v_lshlrev_b32 v5, 16, v4
    v_and_b32 v6, 0xffff0000, v4
    v_lshlrev_b32 v7, 16, v24
    v_and_b32 v10, 0xffff0000, v24
    v_add_f32 v5, v5, v7
    v_add_f32 v6, v6, v10
    v_cvt_pk_bf16_f32 v48, v5, v6
    v_cvt_pk_bf16_f32 v4, v66, v67
    v_lshlrev_b32 v5, 16, v4
    v_and_b32 v6, 0xffff0000, v4
    v_mul_f32 v7, 0xbfb8aa3b, v5
    v_mul_f32 v10, 0xbfb8aa3b, v6
    v_exp_f32 v7, v7
    v_exp_f32 v10, v10
    s_nop 0
    v_add_f32 v7, 1.0, v7
    v_add_f32 v10, 1.0, v10
    v_rcp_f32 v7, v7
    v_rcp_f32 v10, v10
    s_nop 0
    v_mul_f32 v5, v5, v7
    v_mul_f32 v6, v6, v10
    v_cvt_pk_bf16_f32 v4, v5, v6
    v_lshlrev_b32 v5, 16, v4
    v_and_b32 v6, 0xffff0000, v4
    v_lshlrev_b32 v7, 16, v146
    v_lshlrev_b32 v10, 16, v147
    v_mul_f32 v5, v5, v7
    v_mul_f32 v6, v6, v10
    v_cvt_pk_bf16_f32 v4, v5, v6
    v_lshlrev_b32 v5, 16, v4
    v_and_b32 v6, 0xffff0000, v4
    v_lshlrev_b32 v7, 16, v25
    v_and_b32 v10, 0xffff0000, v25
    v_add_f32 v5, v5, v7
    v_add_f32 v6, v6, v10
    v_cvt_pk_bf16_f32 v49, v5, v6
    v_cvt_pk_bf16_f32 v4, v68, v69
    v_lshlrev_b32 v5, 16, v4
    v_and_b32 v6, 0xffff0000, v4
    v_mul_f32 v7, 0xbfb8aa3b, v5
    v_mul_f32 v10, 0xbfb8aa3b, v6
    v_exp_f32 v7, v7
    v_exp_f32 v10, v10
    s_nop 0
    v_add_f32 v7, 1.0, v7
    v_add_f32 v10, 1.0, v10
    v_rcp_f32 v7, v7
    v_rcp_f32 v10, v10
    s_nop 0
    v_mul_f32 v5, v5, v7
    v_mul_f32 v6, v6, v10
    v_cvt_pk_bf16_f32 v4, v5, v6
    v_lshlrev_b32 v5, 16, v4
    v_and_b32 v6, 0xffff0000, v4
    v_lshlrev_b32 v7, 16, v148
    v_lshlrev_b32 v10, 16, v149
    v_mul_f32 v5, v5, v7
    v_mul_f32 v6, v6, v10
    v_cvt_pk_bf16_f32 v4, v5, v6
    v_lshlrev_b32 v5, 16, v4
    v_and_b32 v6, 0xffff0000, v4
    v_lshlrev_b32 v7, 16, v26
    v_and_b32 v10, 0xffff0000, v26
    v_add_f32 v5, v5, v7
    v_add_f32 v6, v6, v10
    v_cvt_pk_bf16_f32 v50, v5, v6
    v_cvt_pk_bf16_f32 v4, v70, v71
    v_lshlrev_b32 v5, 16, v4
    v_and_b32 v6, 0xffff0000, v4
    v_mul_f32 v7, 0xbfb8aa3b, v5
    v_mul_f32 v10, 0xbfb8aa3b, v6
    v_exp_f32 v7, v7
    v_exp_f32 v10, v10
    s_nop 0
    v_add_f32 v7, 1.0, v7
    v_add_f32 v10, 1.0, v10
    v_rcp_f32 v7, v7
    v_rcp_f32 v10, v10
    s_nop 0
    v_mul_f32 v5, v5, v7
    v_mul_f32 v6, v6, v10
    v_cvt_pk_bf16_f32 v4, v5, v6
    v_lshlrev_b32 v5, 16, v4
    v_and_b32 v6, 0xffff0000, v4
    v_lshlrev_b32 v7, 16, v150
    v_lshlrev_b32 v10, 16, v151
    v_mul_f32 v5, v5, v7
    v_mul_f32 v6, v6, v10
    v_cvt_pk_bf16_f32 v4, v5, v6
    v_lshlrev_b32 v5, 16, v4
    v_and_b32 v6, 0xffff0000, v4
    v_lshlrev_b32 v7, 16, v27
    v_and_b32 v10, 0xffff0000, v27
    v_add_f32 v5, v5, v7
    v_add_f32 v6, v6, v10
    v_cvt_pk_bf16_f32 v51, v5, v6
    v_cvt_pk_bf16_f32 v4, v72, v73
    v_lshlrev_b32 v5, 16, v4
    v_and_b32 v6, 0xffff0000, v4
    v_mul_f32 v7, 0xbfb8aa3b, v5
    v_mul_f32 v10, 0xbfb8aa3b, v6
    v_exp_f32 v7, v7
    v_exp_f32 v10, v10
    s_nop 0
    v_add_f32 v7, 1.0, v7
    v_add_f32 v10, 1.0, v10
    v_rcp_f32 v7, v7
    v_rcp_f32 v10, v10
    s_nop 0
    v_mul_f32 v5, v5, v7
    v_mul_f32 v6, v6, v10
    v_cvt_pk_bf16_f32 v4, v5, v6
    v_lshlrev_b32 v5, 16, v4
    v_and_b32 v6, 0xffff0000, v4
    v_lshlrev_b32 v7, 16, v152
    v_lshlrev_b32 v10, 16, v153
    v_mul_f32 v5, v5, v7
    v_mul_f32 v6, v6, v10
    v_cvt_pk_bf16_f32 v4, v5, v6
    v_lshlrev_b32 v5, 16, v4
    v_and_b32 v6, 0xffff0000, v4
    v_lshlrev_b32 v7, 16, v28
    v_and_b32 v10, 0xffff0000, v28
    v_add_f32 v5, v5, v7
    v_add_f32 v6, v6, v10
    v_cvt_pk_bf16_f32 v52, v5, v6
    v_cvt_pk_bf16_f32 v4, v74, v75
    v_lshlrev_b32 v5, 16, v4
    v_and_b32 v6, 0xffff0000, v4
    v_mul_f32 v7, 0xbfb8aa3b, v5
    v_mul_f32 v10, 0xbfb8aa3b, v6
    v_exp_f32 v7, v7
    v_exp_f32 v10, v10
    s_nop 0
    v_add_f32 v7, 1.0, v7
    v_add_f32 v10, 1.0, v10
    v_rcp_f32 v7, v7
    v_rcp_f32 v10, v10
    s_nop 0
    v_mul_f32 v5, v5, v7
    v_mul_f32 v6, v6, v10
    v_cvt_pk_bf16_f32 v4, v5, v6
    v_lshlrev_b32 v5, 16, v4
    v_and_b32 v6, 0xffff0000, v4
    v_lshlrev_b32 v7, 16, v154
    v_lshlrev_b32 v10, 16, v155
    v_mul_f32 v5, v5, v7
    v_mul_f32 v6, v6, v10
    v_cvt_pk_bf16_f32 v4, v5, v6
    v_lshlrev_b32 v5, 16, v4
    v_and_b32 v6, 0xffff0000, v4
    v_lshlrev_b32 v7, 16, v29
    v_and_b32 v10, 0xffff0000, v29
    v_add_f32 v5, v5, v7
    v_add_f32 v6, v6, v10
    v_cvt_pk_bf16_f32 v53, v5, v6
    v_cvt_pk_bf16_f32 v4, v76, v77
    v_lshlrev_b32 v5, 16, v4
    v_and_b32 v6, 0xffff0000, v4
    v_mul_f32 v7, 0xbfb8aa3b, v5
    v_mul_f32 v10, 0xbfb8aa3b, v6
    v_exp_f32 v7, v7
    v_exp_f32 v10, v10
    s_nop 0
    v_add_f32 v7, 1.0, v7
    v_add_f32 v10, 1.0, v10
    v_rcp_f32 v7, v7
    v_rcp_f32 v10, v10
    s_nop 0
    v_mul_f32 v5, v5, v7
    v_mul_f32 v6, v6, v10
    v_cvt_pk_bf16_f32 v4, v5, v6
    v_lshlrev_b32 v5, 16, v4
    v_and_b32 v6, 0xffff0000, v4
    v_lshlrev_b32 v7, 16, v156
    v_lshlrev_b32 v10, 16, v157
    v_mul_f32 v5, v5, v7
    v_mul_f32 v6, v6, v10
    v_cvt_pk_bf16_f32 v4, v5, v6
    v_lshlrev_b32 v5, 16, v4
    v_and_b32 v6, 0xffff0000, v4
    v_lshlrev_b32 v7, 16, v30
    v_and_b32 v10, 0xffff0000, v30
    v_add_f32 v5, v5, v7
    v_add_f32 v6, v6, v10
    v_cvt_pk_bf16_f32 v54, v5, v6
    v_cvt_pk_bf16_f32 v4, v78, v79
    v_lshlrev_b32 v5, 16, v4
    v_and_b32 v6, 0xffff0000, v4
    v_mul_f32 v7, 0xbfb8aa3b, v5
    v_mul_f32 v10, 0xbfb8aa3b, v6
    v_exp_f32 v7, v7
    v_exp_f32 v10, v10
    s_nop 0
    v_add_f32 v7, 1.0, v7
    v_add_f32 v10, 1.0, v10
    v_rcp_f32 v7, v7
    v_rcp_f32 v10, v10
    s_nop 0
    v_mul_f32 v5, v5, v7
    v_mul_f32 v6, v6, v10
    v_cvt_pk_bf16_f32 v4, v5, v6
    v_lshlrev_b32 v5, 16, v4
    v_and_b32 v6, 0xffff0000, v4
    v_lshlrev_b32 v7, 16, v158
    v_lshlrev_b32 v10, 16, v159
    v_mul_f32 v5, v5, v7
    v_mul_f32 v6, v6, v10
    v_cvt_pk_bf16_f32 v4, v5, v6
    v_lshlrev_b32 v5, 16, v4
    v_and_b32 v6, 0xffff0000, v4
    v_lshlrev_b32 v7, 16, v31
    v_and_b32 v10, 0xffff0000, v31
    v_add_f32 v5, v5, v7
    v_add_f32 v6, v6, v10
    v_cvt_pk_bf16_f32 v55, v5, v6
    buffer_store_dwordx4 v[48:51], v22, s[44:47], 0 offen
    buffer_store_dwordx4 v[52:55], v22, s[44:47], 0 offen offset:16
    s_waitcnt vmcnt(0)
    s_endpgm
L_g2_slow_14:
    buffer_load_dword v6, v23, s[52:55], 0 offen sc1
    s_waitcnt vmcnt(0)
    v_cmp_ne_u32 vcc, 0, v6
    s_nop 3
    s_and_b32 s36, vcc_lo, 0x3fff
    s_bitcmp1_b32 s36, s26
    s_cbranch_scc1 L_g2_back_15
    s_add_u32 s39, s39, 1
    s_cmp_ge_u32 s39, 0x100000
    s_cbranch_scc1 L_g2_back_15
    s_sleep 4
    s_branch L_g2_slow_14
L_g2_slow_16:
    buffer_load_dword v6, v23, s[52:55], 0 offen sc1
    s_waitcnt vmcnt(0)
    v_cmp_ne_u32 vcc, 0, v6
    s_nop 3
    s_and_b32 s36, vcc_lo, 0x3fff
    s_bitcmp1_b32 s36, s26
    s_cbranch_scc1 L_g2_back_17
    s_add_u32 s39, s39, 1
    s_cmp_ge_u32 s39, 0x100000
    s_cbranch_scc1 L_g2_back_17
    s_sleep 4
    s_branch L_g2_slow_16
L_g2_slow_18:
    buffer_load_dword v6, v23, s[52:55], 0 offen sc1
    s_waitcnt vmcnt(0)
    v_cmp_ne_u32 vcc, 0, v6
    s_nop 3
    s_and_b32 s36, vcc_lo, 0x3fff
    s_bitcmp1_b32 s36, s26
    s_cbranch_scc1 L_g2_back_19
    s_add_u32 s39, s39, 1
    s_cmp_ge_u32 s39, 0x100000
    s_cbranch_scc1 L_g2_back_19
    s_sleep 4
    s_branch L_g2_slow_18
L_g2_slow_20:
    buffer_load_dword v6, v23, s[52:55], 0 offen sc1
    s_waitcnt vmcnt(0)
    v_cmp_ne_u32 vcc, 0, v6
    s_nop 3
    s_and_b32 s36, vcc_lo, 0x3fff
    s_bitcmp1_b32 s36, s26
    s_cbranch_scc1 L_g2_back_21
    s_add_u32 s39, s39, 1
    s_cmp_ge_u32 s39, 0x100000
    s_cbranch_scc1 L_g2_back_21
    s_sleep 4
    s_branch L_g2_slow_20
L_g2_slow_22:
    buffer_load_dword v6, v23, s[52:55], 0 offen sc1
    s_waitcnt vmcnt(0)
    v_cmp_ne_u32 vcc, 0, v6
    s_nop 3
    s_and_b32 s36, vcc_lo, 0x3fff
    s_bitcmp1_b32 s36, s26
    s_cbranch_scc1 L_g2_back_23
    s_add_u32 s39, s39, 1
    s_cmp_ge_u32 s39, 0x100000
    s_cbranch_scc1 L_g2_back_23
    s_sleep 4
    s_branch L_g2_slow_22
L_g2_slow_24:
    buffer_load_dword v6, v23, s[52:55], 0 offen sc1
    s_waitcnt vmcnt(0)
    v_cmp_ne_u32 vcc, 0, v6
    s_nop 3
    s_and_b32 s36, vcc_lo, 0x3fff
    s_bitcmp1_b32 s36, s26
    s_cbranch_scc1 L_g2_back_25
    s_add_u32 s39, s39, 1
    s_cmp_ge_u32 s39, 0x100000
    s_cbranch_scc1 L_g2_back_25
    s_sleep 4
    s_branch L_g2_slow_24
L_g2_slow_26:
    buffer_load_dword v6, v23, s[52:55], 0 offen sc1
    s_waitcnt vmcnt(0)
    v_cmp_ne_u32 vcc, 0, v6
    s_nop 3
    s_and_b32 s36, vcc_lo, 0x3fff
    s_bitcmp1_b32 s36, s26
    s_cbranch_scc1 L_g2_back_27
    s_add_u32 s39, s39, 1
    s_cmp_ge_u32 s39, 0x100000
    s_cbranch_scc1 L_g2_back_27
    s_sleep 4
    s_branch L_g2_slow_26
L_g2_slow_28:
    buffer_load_dword v6, v23, s[52:55], 0 offen sc1
    s_waitcnt vmcnt(0)
    v_cmp_ne_u32 vcc, 0, v6
    s_nop 3
    s_and_b32 s36, vcc_lo, 0x3fff
    s_bitcmp1_b32 s36, s26
    s_cbranch_scc1 L_g2_back_29
    s_add_u32 s39, s39, 1
    s_cmp_ge_u32 s39, 0x100000
    s_cbranch_scc1 L_g2_back_29
    s_sleep 4
    s_branch L_g2_slow_28
L_g2_slow_30:
    buffer_load_dword v6, v23, s[52:55], 0 offen sc1
    s_waitcnt vmcnt(0)
    v_cmp_ne_u32 vcc, 0, v6
    s_nop 3
    s_and_b32 s36, vcc_lo, 0x3fff
    s_bitcmp1_b32 s36, s26
    s_cbranch_scc1 L_g2_back_31
    s_add_u32 s39, s39, 1
    s_cmp_ge_u32 s39, 0x100000
    s_cbranch_scc1 L_g2_back_31
    s_sleep 4
    s_branch L_g2_slow_30
L_g2_slow_32:
    buffer_load_dword v6, v23, s[52:55], 0 offen sc1
    s_waitcnt vmcnt(0)
    v_cmp_ne_u32 vcc, 0, v6
    s_nop 3
    s_and_b32 s36, vcc_lo, 0x3fff
    s_bitcmp1_b32 s36, s26
    s_cbranch_scc1 L_g2_back_33
    s_add_u32 s39, s39, 1
    s_cmp_ge_u32 s39, 0x100000
    s_cbranch_scc1 L_g2_back_33
    s_sleep 4
    s_branch L_g2_slow_32
L_g2_slow_34:
    buffer_load_dword v6, v23, s[52:55], 0 offen sc1
    s_waitcnt vmcnt(0)
    v_cmp_ne_u32 vcc, 0, v6
    s_nop 3
    s_and_b32 s36, vcc_lo, 0x3fff
    s_bitcmp1_b32 s36, s26
    s_cbranch_scc1 L_g2_back_35
    s_add_u32 s39, s39, 1
    s_cmp_ge_u32 s39, 0x100000
    s_cbranch_scc1 L_g2_back_35
    s_sleep 4
    s_branch L_g2_slow_34
L_g2_slow_36:
    buffer_load_dword v6, v23, s[52:55], 0 offen sc1
    s_waitcnt vmcnt(0)
    v_cmp_ne_u32 vcc, 0, v6
    s_nop 3
    s_and_b32 s36, vcc_lo, 0x3fff
    s_bitcmp1_b32 s36, s26
    s_cbranch_scc1 L_g2_back_37
    s_add_u32 s39, s39, 1
    s_cmp_ge_u32 s39, 0x100000
    s_cbranch_scc1 L_g2_back_37
    s_sleep 4
    s_branch L_g2_slow_36
L_g2_slow_38:
    buffer_load_dword v6, v23, s[52:55], 0 offen sc1
    s_waitcnt vmcnt(0)
    v_cmp_ne_u32 vcc, 0, v6
    s_nop 3
    s_and_b32 s36, vcc_lo, 0x3fff
    s_bitcmp1_b32 s36, s26
    s_cbranch_scc1 L_g2_back_39
    s_add_u32 s39, s39, 1
    s_cmp_ge_u32 s39, 0x100000
    s_cbranch_scc1 L_g2_back_39
    s_sleep 4
    s_branch L_g2_slow_38
L_g2_slow_40:
    buffer_load_dword v6, v23, s[52:55], 0 offen sc1
    s_waitcnt vmcnt(0)
    v_cmp_ne_u32 vcc, 0, v6
    s_nop 3
    s_and_b32 s36, vcc_lo, 0x3fff
    s_bitcmp1_b32 s36, s26
    s_cbranch_scc1 L_g2_back_41
    s_add_u32 s39, s39, 1
    s_cmp_ge_u32 s39, 0x100000
    s_cbranch_scc1 L_g2_back_41
    s_sleep 4
    s_branch L_g2_slow_40
kb_kernel_conv:
    s_sub_u32 s3, s2, 256
    s_setprio 0
    s_add_u32 s8, s6, 4194304
    s_addc_u32 s9, s7, 0
    s_mov_b32 s10, 1892352
    s_mov_b32 s11, 0x00020000
    s_add_u32 s12, s6, 2097152
    s_addc_u32 s13, s7, 0
    s_mov_b32 s14, 1835008
    s_mov_b32 s15, 0x00020000
    s_add_u32 s16, s6, 14680064
    s_addc_u32 s17, s7, 0
    s_mov_b32 s18, 1835008
    s_mov_b32 s19, 0x00020000
    s_mov_b32 s20, s76
    s_mov_b32 s21, s77
    s_mov_b32 s22, 896
    s_mov_b32 s23, 0x00020000
    v_lshrrev_b32 v1, 7, v0
    v_and_b32 v2, 127, v0
    s_lshl_b32 s24, s3, 1
    v_add_u32 v3, s24, v1

    v_mul_u32_u24 v4, 4224, v3
    v_lshl_add_u32 v4, v2, 4, v4
    v_lshlrev_b32 v5, 12, v3
    v_lshl_add_u32 v5, v2, 4, v5
    v_lshlrev_b32 v6, 1, v3
    buffer_load_dwordx4 v[16:19], v4, s[8:11], 0 offen
    buffer_load_dwordx4 v[20:23], v4, s[8:11], 0 offen offset:16
    buffer_load_dwordx4 v[24:27], v4, s[8:11], 0 offen offset:2048
    buffer_load_dwordx4 v[28:31], v4, s[8:11], 0 offen offset:2064
    buffer_load_dwordx4 v[32:35], v5, s[12:15], 0 offen
    buffer_load_dwordx4 v[36:39], v5, s[12:15], 0 offen offset:2048
    buffer_load_ushort v7, v6, s[20:23], 0 offen
    v_mul_u32_u24 v8, 40880, v1
    v_lshl_add_u32 v9, v2, 4, v8
    v_mov_b32 v40, 0
    v_mov_b32 v41, 0
    v_mov_b32 v42, 0
    v_mov_b32 v43, 0
    ds_write_b128 v9, v[40:43] offset:33280
    v_cmp_gt_u32 vcc, 27, v2
    s_and_saveexec_b64 s[26:27], vcc
    ds_write_b128 v9, v[40:43] offset:35328
    s_mov_b64 exec, s[26:27]
    v_lshrrev_b32 v10, 2, v2
    v_mul_u32_u24 v10, 4160, v10
    v_and_b32 v11, 3, v2
    v_lshl_add_u32 v10, v11, 4, v10
    v_add_u32 v10, v10, v8
    v_cmp_gt_u32 vcc, 32, v2
    s_and_saveexec_b64 s[26:27], vcc
    ds_write_b128 v10, v[40:43] offset:4096
    s_mov_b64 exec, s[26:27]
    v_lshrrev_b32 v10, 2, v2
    v_mul_u32_u24 v10, 80, v10
    v_lshl_add_u32 v10, v11, 4, v10
    v_add_u32 v10, v10, v8
    s_waitcnt vmcnt(0)
    ds_write_b128 v10, v[32:35] offset:35760
    ds_write_b128 v10, v[36:39] offset:38320
    v_alignbit_b32 v44, v17, v16, 16
    v_alignbit_b32 v45, v18, v17, 16
    v_alignbit_b32 v46, v19, v18, 16
    v_alignbit_b32 v47, v20, v19, 16
    v_alignbit_b32 v48, v21, v20, 16
    v_alignbit_b32 v49, v22, v21, 16
    v_alignbit_b32 v50, v23, v22, 16
    v_mov_b32 v52, v17
    v_mov_b32 v53, v18
    v_mov_b32 v54, v19
    v_mov_b32 v55, v20
    v_mov_b32 v56, v21
    v_mov_b32 v57, v22
    v_alignbit_b32 v60, v18, v17, 16
    v_alignbit_b32 v61, v19, v18, 16
    v_alignbit_b32 v62, v20, v19, 16
    v_alignbit_b32 v63, v21, v20, 16
    v_alignbit_b32 v64, v22, v21, 16
    v_alignbit_b32 v65, v23, v22, 16
    ds_write_b128 v9, v[16:19] offset:0
    ds_write_b128 v9, v[44:47] offset:4160
    ds_write_b128 v9, v[52:55] offset:8320
    ds_write_b128 v9, v[60:63] offset:12480
    ds_write_b128 v9, v[18:21] offset:16640
    ds_write_b128 v9, v[46:49] offset:20800
    ds_write_b128 v9, v[54:57] offset:24960
    ds_write_b128 v9, v[62:65] offset:29120
    v_alignbit_b32 v44, v25, v24, 16
    v_alignbit_b32 v45, v26, v25, 16
    v_alignbit_b32 v46, v27, v26, 16
    v_alignbit_b32 v47, v28, v27, 16
    v_alignbit_b32 v48, v29, v28, 16
    v_alignbit_b32 v49, v30, v29, 16
    v_alignbit_b32 v50, v31, v30, 16
    v_mov_b32 v52, v25
    v_mov_b32 v53, v26
    v_mov_b32 v54, v27
    v_mov_b32 v55, v28
    v_mov_b32 v56, v29
    v_mov_b32 v57, v30
    v_alignbit_b32 v60, v26, v25, 16
    v_alignbit_b32 v61, v27, v26, 16
    v_alignbit_b32 v62, v28, v27, 16
    v_alignbit_b32 v63, v29, v28, 16
    v_alignbit_b32 v64, v30, v29, 16
    v_alignbit_b32 v65, v31, v30, 16
    ds_write_b128 v9, v[24:27] offset:2048
    ds_write_b128 v9, v[44:47] offset:6208
    ds_write_b128 v9, v[52:55] offset:10368
    ds_write_b128 v9, v[60:63] offset:14528
    ds_write_b128 v9, v[26:29] offset:18688
    ds_write_b128 v9, v[46:49] offset:22848
    ds_write_b128 v9, v[54:57] offset:27008
    ds_write_b128 v9, v[62:65] offset:31168
    v_lshlrev_b32 v7, 16, v7
    s_waitcnt lgkmcnt(0)
    s_barrier
    v_and_b32 v10, 63, v0
    v_and_b32 v11, 31, v10
    v_lshrrev_b32 v12, 5, v10
    v_sub_u32 v13, 7, v11
    v_and_b32 v13, 7, v13

    v_mul_u32_u24 v13, 4160, v13
    v_lshl_add_u32 v13, v12, 4, v13
    v_lshrrev_b32 v14, 3, v11
    v_lshlrev_b32 v14, 4, v14
    v_sub_u32 v13, v13, v14
    v_add_u32 v13, 48, v13
    v_add_u32 v13, v13, v8
    v_mul_u32_u24 v14, 80, v11
    v_lshl_add_u32 v14, v12, 4, v14
    v_add_u32 v14, 33280, v14
    v_add_u32 v14, v14, v8
    v_mov_b32 v64, 0
    v_mov_b32 v65, 0
    v_mov_b32 v66, 0
    v_mov_b32 v67, 0
    v_mov_b32 v68, 0
    v_mov_b32 v69, 0
    v_mov_b32 v70, 0
    v_mov_b32 v71, 0
    v_mov_b32 v72, 0
    v_mov_b32 v73, 0
    v_mov_b32 v74, 0
    v_mov_b32 v75, 0
    v_mov_b32 v76, 0
    v_mov_b32 v77, 0
    v_mov_b32 v78, 0
    v_mov_b32 v79, 0
    v_mov_b32 v80, 0
    v_mov_b32 v81, 0
    v_mov_b32 v82, 0
    v_mov_b32 v83, 0
    v_mov_b32 v84, 0
    v_mov_b32 v85, 0
    v_mov_b32 v86, 0
    v_mov_b32 v87, 0
    v_mov_b32 v88, 0
    v_mov_b32 v89, 0
    v_mov_b32 v90, 0
    v_mov_b32 v91, 0
    v_mov_b32 v92, 0
    v_mov_b32 v93, 0
    v_mov_b32 v94, 0
    v_mov_b32 v95, 0
    v_lshrrev_b32 v15, 6, v0
    v_and_b32 v15, 1, v15
    s_nop 0
    v_readfirstlane_b32 s25, v15
    s_nop 3
    s_mul_i32 s26, s25, 1024
    s_mul_i32 s27, s25, 1280
    v_subrev_u32 v18, s26, v13
    v_subrev_u32 v19, s27, v14
    ds_read_b128 v[96:99], v18 offset:4032
    ds_read_b128 v[112:115], v19 offset:2480
    ds_read_b128 v[100:103], v18 offset:4064
    ds_read_b128 v[116:119], v19 offset:2512
    ds_read_b128 v[104:107], v18 offset:1984
    ds_read_b128 v[120:123], v19 offset:5040
    ds_read_b128 v[108:111], v18 offset:2016
    ds_read_b128 v[124:127], v19 offset:5072
    ds_read_b128 v[128:131], v18 offset:3968
    ds_read_b128 v[144:147], v19 offset:2400
    ds_read_b128 v[132:135], v18 offset:4000
    ds_read_b128 v[148:151], v19 offset:2432
    ds_read_b128 v[136:139], v18 offset:1920
    ds_read_b128 v[152:155], v19 offset:4960
    ds_read_b128 v[140:143], v18 offset:1952
    ds_read_b128 v[156:159], v19 offset:4992
    s_waitcnt lgkmcnt(8)
    v_mfma_f32_32x32x16_bf16 v[64:79], v[96:99], v[112:115], v[64:79]
    v_mfma_f32_32x32x16_bf16 v[80:95], v[104:107], v[112:115], v[80:95]
    v_mfma_f32_32x32x16_bf16 v[80:95], v[96:99], v[120:123], v[80:95]
    v_mfma_f32_32x32x16_bf16 v[64:79], v[100:103], v[116:119], v[64:79]
    v_mfma_f32_32x32x16_bf16 v[80:95], v[108:111], v[116:119], v[80:95]
    v_mfma_f32_32x32x16_bf16 v[80:95], v[100:103], v[124:127], v[80:95]
    ds_read_b128 v[96:99], v18 offset:3904
    ds_read_b128 v[112:115], v19 offset:2320
    ds_read_b128 v[100:103], v18 offset:3936
    ds_read_b128 v[116:119], v19 offset:2352
    ds_read_b128 v[104:107], v18 offset:1856
    ds_read_b128 v[120:123], v19 offset:4880
    ds_read_b128 v[108:111], v18 offset:1888
    ds_read_b128 v[124:127], v19 offset:4912
    s_waitcnt lgkmcnt(8)
    v_mfma_f32_32x32x16_bf16 v[64:79], v[128:131], v[144:147], v[64:79]
    v_mfma_f32_32x32x16_bf16 v[80:95], v[136:139], v[144:147], v[80:95]
    v_mfma_f32_32x32x16_bf16 v[80:95], v[128:131], v[152:155], v[80:95]
    v_mfma_f32_32x32x16_bf16 v[64:79], v[132:135], v[148:151], v[64:79]
    v_mfma_f32_32x32x16_bf16 v[80:95], v[140:143], v[148:151], v[80:95]
    v_mfma_f32_32x32x16_bf16 v[80:95], v[132:135], v[156:159], v[80:95]
    ds_read_b128 v[128:131], v18 offset:3840
    ds_read_b128 v[144:147], v19 offset:2240
    ds_read_b128 v[132:135], v18 offset:3872
    ds_read_b128 v[148:151], v19 offset:2272
    ds_read_b128 v[136:139], v18 offset:1792
    ds_read_b128 v[152:155], v19 offset:4800
    ds_read_b128 v[140:143], v18 offset:1824
    ds_read_b128 v[156:159], v19 offset:4832
    s_waitcnt lgkmcnt(8)
    v_mfma_f32_32x32x16_bf16 v[64:79], v[96:99], v[112:115], v[64:79]
    v_mfma_f32_32x32x16_bf16 v[80:95], v[104:107], v[112:115], v[80:95]
    v_mfma_f32_32x32x16_bf16 v[80:95], v[96:99], v[120:123], v[80:95]
    v_mfma_f32_32x32x16_bf16 v[64:79], v[100:103], v[116:119], v[64:79]
    v_mfma_f32_32x32x16_bf16 v[80:95], v[108:111], v[116:119], v[80:95]
    v_mfma_f32_32x32x16_bf16 v[80:95], v[100:103], v[124:127], v[80:95]
    ds_read_b128 v[96:99], v18 offset:3776
    ds_read_b128 v[112:115], v19 offset:2160
    ds_read_b128 v[100:103], v18 offset:3808
    ds_read_b128 v[116:119], v19 offset:2192
    ds_read_b128 v[104:107], v18 offset:1728
    ds_read_b128 v[120:123], v19 offset:4720
    ds_read_b128 v[108:111], v18 offset:1760
    ds_read_b128 v[124:127], v19 offset:4752
    s_waitcnt lgkmcnt(8)
    v_mfma_f32_32x32x16_bf16 v[64:79], v[128:131], v[144:147], v[64:79]
    v_mfma_f32_32x32x16_bf16 v[80:95], v[136:139], v[144:147], v[80:95]
    v_mfma_f32_32x32x16_bf16 v[80:95], v[128:131], v[152:155], v[80:95]
    v_mfma_f32_32x32x16_bf16 v[64:79], v[132:135], v[148:151], v[64:79]
    v_mfma_f32_32x32x16_bf16 v[80:95], v[140:143], v[148:151], v[80:95]
    v_mfma_f32_32x32x16_bf16 v[80:95], v[132:135], v[156:159], v[80:95]
    ds_read_b128 v[128:131], v18 offset:3712
    ds_read_b128 v[144:147], v19 offset:2080
    ds_read_b128 v[132:135], v18 offset:3744
    ds_read_b128 v[148:151], v19 offset:2112
    ds_read_b128 v[136:139], v18 offset:1664
    ds_read_b128 v[152:155], v19 offset:4640
    ds_read_b128 v[140:143], v18 offset:1696
    ds_read_b128 v[156:159], v19 offset:4672
    s_waitcnt lgkmcnt(8)
    v_mfma_f32_32x32x16_bf16 v[64:79], v[96:99], v[112:115], v[64:79]
    v_mfma_f32_32x32x16_bf16 v[80:95], v[104:107], v[112:115], v[80:95]
    v_mfma_f32_32x32x16_bf16 v[80:95], v[96:99], v[120:123], v[80:95]
    v_mfma_f32_32x32x16_bf16 v[64:79], v[100:103], v[116:119], v[64:79]
    v_mfma_f32_32x32x16_bf16 v[80:95], v[108:111], v[116:119], v[80:95]
    v_mfma_f32_32x32x16_bf16 v[80:95], v[100:103], v[124:127], v[80:95]
    ds_read_b128 v[96:99], v18 offset:3648
    ds_read_b128 v[112:115], v19 offset:2000
    ds_read_b128 v[100:103], v18 offset:3680
    ds_read_b128 v[116:119], v19 offset:2032
    ds_read_b128 v[104:107], v18 offset:1600
    ds_read_b128 v[120:123], v19 offset:4560
    ds_read_b128 v[108:111], v18 offset:1632
    ds_read_b128 v[124:127], v19 offset:4592
    s_waitcnt lgkmcnt(8)
    v_mfma_f32_32x32x16_bf16 v[64:79], v[128:131], v[144:147], v[64:79]
    v_mfma_f32_32x32x16_bf16 v[80:95], v[136:139], v[144:147], v[80:95]
    v_mfma_f32_32x32x16_bf16 v[80:95], v[128:131], v[152:155], v[80:95]
    v_mfma_f32_32x32x16_bf16 v[64:79], v[132:135], v[148:151], v[64:79]
    v_mfma_f32_32x32x16_bf16 v[80:95], v[140:143], v[148:151], v[80:95]
    v_mfma_f32_32x32x16_bf16 v[80:95], v[132:135], v[156:159], v[80:95]
    ds_read_b128 v[128:131], v18 offset:3584
    ds_read_b128 v[144:147], v19 offset:1920
    ds_read_b128 v[132:135], v18 offset:3616
    ds_read_b128 v[148:151], v19 offset:1952
    ds_read_b128 v[136:139], v18 offset:1536
    ds_read_b128 v[152:155], v19 offset:4480
    ds_read_b128 v[140:143], v18 offset:1568
    ds_read_b128 v[156:159], v19 offset:4512
    s_waitcnt lgkmcnt(8)
    v_mfma_f32_32x32x16_bf16 v[64:79], v[96:99], v[112:115], v[64:79]
    v_mfma_f32_32x32x16_bf16 v[80:95], v[104:107], v[112:115], v[80:95]
    v_mfma_f32_32x32x16_bf16 v[80:95], v[96:99], v[120:123], v[80:95]
    v_mfma_f32_32x32x16_bf16 v[64:79], v[100:103], v[116:119], v[64:79]
    v_mfma_f32_32x32x16_bf16 v[80:95], v[108:111], v[116:119], v[80:95]
    v_mfma_f32_32x32x16_bf16 v[80:95], v[100:103], v[124:127], v[80:95]
    ds_read_b128 v[96:99], v18 offset:3520
    ds_read_b128 v[112:115], v19 offset:1840
    ds_read_b128 v[100:103], v18 offset:3552
    ds_read_b128 v[116:119], v19 offset:1872
    ds_read_b128 v[104:107], v18 offset:1472
    ds_read_b128 v[120:123], v19 offset:4400
    ds_read_b128 v[108:111], v18 offset:1504
    ds_read_b128 v[124:127], v19 offset:4432
    s_waitcnt lgkmcnt(8)
    v_mfma_f32_32x32x16_bf16 v[64:79], v[128:131], v[144:147], v[64:79]
    v_mfma_f32_32x32x16_bf16 v[80:95], v[136:139], v[144:147], v[80:95]
    v_mfma_f32_32x32x16_bf16 v[80:95], v[128:131], v[152:155], v[80:95]
    v_mfma_f32_32x32x16_bf16 v[64:79], v[132:135], v[148:151], v[64:79]
    v_mfma_f32_32x32x16_bf16 v[80:95], v[140:143], v[148:151], v[80:95]
    v_mfma_f32_32x32x16_bf16 v[80:95], v[132:135], v[156:159], v[80:95]
    ds_read_b128 v[128:131], v18 offset:3456
    ds_read_b128 v[144:147], v19 offset:1760
    ds_read_b128 v[132:135], v18 offset:3488
    ds_read_b128 v[148:151], v19 offset:1792
    ds_read_b128 v[136:139], v18 offset:1408
    ds_read_b128 v[152:155], v19 offset:4320
    ds_read_b128 v[140:143], v18 offset:1440
    ds_read_b128 v[156:159], v19 offset:4352
    s_waitcnt lgkmcnt(8)
    v_mfma_f32_32x32x16_bf16 v[64:79], v[96:99], v[112:115], v[64:79]
    v_mfma_f32_32x32x16_bf16 v[80:95], v[104:107], v[112:115], v[80:95]
    v_mfma_f32_32x32x16_bf16 v[80:95], v[96:99], v[120:123], v[80:95]
    v_mfma_f32_32x32x16_bf16 v[64:79], v[100:103], v[116:119], v[64:79]
    v_mfma_f32_32x32x16_bf16 v[80:95], v[108:111], v[116:119], v[80:95]
    v_mfma_f32_32x32x16_bf16 v[80:95], v[100:103], v[124:127], v[80:95]
    ds_read_b128 v[96:99], v18 offset:3392
    ds_read_b128 v[112:115], v19 offset:1680
    ds_read_b128 v[100:103], v18 offset:3424
    ds_read_b128 v[116:119], v19 offset:1712
    ds_read_b128 v[104:107], v18 offset:1344
    ds_read_b128 v[120:123], v19 offset:4240
    ds_read_b128 v[108:111], v18 offset:1376
    ds_read_b128 v[124:127], v19 offset:4272
    s_waitcnt lgkmcnt(8)
    v_mfma_f32_32x32x16_bf16 v[64:79], v[128:131], v[144:147], v[64:79]
    v_mfma_f32_32x32x16_bf16 v[80:95], v[136:139], v[144:147], v[80:95]
    v_mfma_f32_32x32x16_bf16 v[80:95], v[128:131], v[152:155], v[80:95]
    v_mfma_f32_32x32x16_bf16 v[64:79], v[132:135], v[148:151], v[64:79]
    v_mfma_f32_32x32x16_bf16 v[80:95], v[140:143], v[148:151], v[80:95]
    v_mfma_f32_32x32x16_bf16 v[80:95], v[132:135], v[156:159], v[80:95]
    ds_read_b128 v[128:131], v18 offset:3328
    ds_read_b128 v[144:147], v19 offset:1600
    ds_read_b128 v[132:135], v18 offset:3360
    ds_read_b128 v[148:151], v19 offset:1632
    ds_read_b128 v[136:139], v18 offset:1280
    ds_read_b128 v[152:155], v19 offset:4160
    ds_read_b128 v[140:143], v18 offset:1312
    ds_read_b128 v[156:159], v19 offset:4192
    s_waitcnt lgkmcnt(8)
    v_mfma_f32_32x32x16_bf16 v[64:79], v[96:99], v[112:115], v[64:79]
    v_mfma_f32_32x32x16_bf16 v[80:95], v[104:107], v[112:115], v[80:95]
    v_mfma_f32_32x32x16_bf16 v[80:95], v[96:99], v[120:123], v[80:95]
    v_mfma_f32_32x32x16_bf16 v[64:79], v[100:103], v[116:119], v[64:79]
    v_mfma_f32_32x32x16_bf16 v[80:95], v[108:111], v[116:119], v[80:95]
    v_mfma_f32_32x32x16_bf16 v[80:95], v[100:103], v[124:127], v[80:95]
    ds_read_b128 v[96:99], v18 offset:3264
    ds_read_b128 v[112:115], v19 offset:1520
    ds_read_b128 v[100:103], v18 offset:3296
    ds_read_b128 v[116:119], v19 offset:1552
    ds_read_b128 v[104:107], v18 offset:1216
    ds_read_b128 v[120:123], v19 offset:4080
    ds_read_b128 v[108:111], v18 offset:1248
    ds_read_b128 v[124:127], v19 offset:4112
    s_waitcnt lgkmcnt(8)
    v_mfma_f32_32x32x16_bf16 v[64:79], v[128:131], v[144:147], v[64:79]
    v_mfma_f32_32x32x16_bf16 v[80:95], v[136:139], v[144:147], v[80:95]
    v_mfma_f32_32x32x16_bf16 v[80:95], v[128:131], v[152:155], v[80:95]
    v_mfma_f32_32x32x16_bf16 v[64:79], v[132:135], v[148:151], v[64:79]
    v_mfma_f32_32x32x16_bf16 v[80:95], v[140:143], v[148:151], v[80:95]
    v_mfma_f32_32x32x16_bf16 v[80:95], v[132:135], v[156:159], v[80:95]
    ds_read_b128 v[128:131], v18 offset:3200
    ds_read_b128 v[144:147], v19 offset:1440
    ds_read_b128 v[132:135], v18 offset:3232
    ds_read_b128 v[148:151], v19 offset:1472
    ds_read_b128 v[136:139], v18 offset:1152
    ds_read_b128 v[152:155], v19 offset:4000
    ds_read_b128 v[140:143], v18 offset:1184
    ds_read_b128 v[156:159], v19 offset:4032
    s_waitcnt lgkmcnt(8)
    v_mfma_f32_32x32x16_bf16 v[64:79], v[96:99], v[112:115], v[64:79]
    v_mfma_f32_32x32x16_bf16 v[80:95], v[104:107], v[112:115], v[80:95]
    v_mfma_f32_32x32x16_bf16 v[80:95], v[96:99], v[120:123], v[80:95]
    v_mfma_f32_32x32x16_bf16 v[64:79], v[100:103], v[116:119], v[64:79]
    v_mfma_f32_32x32x16_bf16 v[80:95], v[108:111], v[116:119], v[80:95]
    v_mfma_f32_32x32x16_bf16 v[80:95], v[100:103], v[124:127], v[80:95]
    ds_read_b128 v[96:99], v18 offset:3136
    ds_read_b128 v[112:115], v19 offset:1360
    ds_read_b128 v[100:103], v18 offset:3168
    ds_read_b128 v[116:119], v19 offset:1392
    ds_read_b128 v[104:107], v18 offset:1088
    ds_read_b128 v[120:123], v19 offset:3920
    ds_read_b128 v[108:111], v18 offset:1120
    ds_read_b128 v[124:127], v19 offset:3952
    s_waitcnt lgkmcnt(8)
    v_mfma_f32_32x32x16_bf16 v[64:79], v[128:131], v[144:147], v[64:79]
    v_mfma_f32_32x32x16_bf16 v[80:95], v[136:139], v[144:147], v[80:95]
    v_mfma_f32_32x32x16_bf16 v[80:95], v[128:131], v[152:155], v[80:95]
    v_mfma_f32_32x32x16_bf16 v[64:79], v[132:135], v[148:151], v[64:79]
    v_mfma_f32_32x32x16_bf16 v[80:95], v[140:143], v[148:151], v[80:95]
    v_mfma_f32_32x32x16_bf16 v[80:95], v[132:135], v[156:159], v[80:95]
    ds_read_b128 v[128:131], v18 offset:3072
    ds_read_b128 v[144:147], v19 offset:1280
    ds_read_b128 v[132:135], v18 offset:3104
    ds_read_b128 v[148:151], v19 offset:1312
    ds_read_b128 v[136:139], v18 offset:1024
    ds_read_b128 v[152:155], v19 offset:3840
    ds_read_b128 v[140:143], v18 offset:1056
    ds_read_b128 v[156:159], v19 offset:3872
    s_waitcnt lgkmcnt(8)
    v_mfma_f32_32x32x16_bf16 v[64:79], v[96:99], v[112:115], v[64:79]
    v_mfma_f32_32x32x16_bf16 v[80:95], v[104:107], v[112:115], v[80:95]
    v_mfma_f32_32x32x16_bf16 v[80:95], v[96:99], v[120:123], v[80:95]
    v_mfma_f32_32x32x16_bf16 v[64:79], v[100:103], v[116:119], v[64:79]
    v_mfma_f32_32x32x16_bf16 v[80:95], v[108:111], v[116:119], v[80:95]
    v_mfma_f32_32x32x16_bf16 v[80:95], v[100:103], v[124:127], v[80:95]
    s_waitcnt lgkmcnt(0)
    v_mfma_f32_32x32x16_bf16 v[64:79], v[128:131], v[144:147], v[64:79]
    v_mfma_f32_32x32x16_bf16 v[80:95], v[136:139], v[144:147], v[80:95]
    v_mfma_f32_32x32x16_bf16 v[80:95], v[128:131], v[152:155], v[80:95]
    v_mfma_f32_32x32x16_bf16 v[64:79], v[132:135], v[148:151], v[64:79]
    v_mfma_f32_32x32x16_bf16 v[80:95], v[140:143], v[148:151], v[80:95]
    v_mfma_f32_32x32x16_bf16 v[80:95], v[132:135], v[156:159], v[80:95]
    s_nop 15
    s_barrier
    v_lshl_add_u32 v15, v10, 4, v8
    s_lshl_b32 s26, s25, 12
    v_add_u32 v18, s26, v15
    s_xor_b32 s26, s26, 4096
    v_add_u32 v19, s26, v15
    s_cmp_eq_u32 s25, 1
    s_cbranch_scc1 L_cv_B2_44
    ds_write_b128 v18, v[80:83] offset:0
    ds_write_b128 v18, v[84:87] offset:1024
    ds_write_b128 v18, v[88:91] offset:2048
    ds_write_b128 v18, v[92:95] offset:3072
    s_branch L_cv_J2_45
L_cv_B2_44:
    ds_write_b128 v18, v[64:67] offset:0
    ds_write_b128 v18, v[68:71] offset:1024
    ds_write_b128 v18, v[72:75] offset:2048
    ds_write_b128 v18, v[76:79] offset:3072
    v_mov_b32 v64, v80
    v_mov_b32 v65, v81
    v_mov_b32 v66, v82
    v_mov_b32 v67, v83
    v_mov_b32 v68, v84
    v_mov_b32 v69, v85
    v_mov_b32 v70, v86
    v_mov_b32 v71, v87
    v_mov_b32 v72, v88
    v_mov_b32 v73, v89
    v_mov_b32 v74, v90
    v_mov_b32 v75, v91
    v_mov_b32 v76, v92
    v_mov_b32 v77, v93
    v_mov_b32 v78, v94
    v_mov_b32 v79, v95
L_cv_J2_45:
    s_waitcnt lgkmcnt(0)
    s_barrier
    ds_read_b128 v[96:99], v19 offset:0
    ds_read_b128 v[100:103], v19 offset:1024
    ds_read_b128 v[104:107], v19 offset:2048
    ds_read_b128 v[108:111], v19 offset:3072
    s_waitcnt lgkmcnt(0)
    v_add_f32 v64, v64, v96
    v_add_f32 v65, v65, v97
    v_add_f32 v66, v66, v98
    v_add_f32 v67, v67, v99
    v_add_f32 v68, v68, v100
    v_add_f32 v69, v69, v101
    v_add_f32 v70, v70, v102
    v_add_f32 v71, v71, v103
    v_add_f32 v72, v72, v104
    v_add_f32 v73, v73, v105
    v_add_f32 v74, v74, v106
    v_add_f32 v75, v75, v107
    v_add_f32 v76, v76, v108
    v_add_f32 v77, v77, v109
    v_add_f32 v78, v78, v110
    v_add_f32 v79, v79, v111
    v_lshlrev_b32 v16, 3, v12
    v_sub_u32 v16, v14, v16
    s_mul_i32 s26, s25, 2560
    v_add_u32 v16, s26, v16
    ds_read_b64 v[96:97], v16 offset:2480
    ds_read_b64 v[98:99], v16 offset:2496
    ds_read_b64 v[100:101], v16 offset:2512
    ds_read_b64 v[102:103], v16 offset:2528
    v_lshlrev_b32 v17, 12, v3
    v_lshl_add_u32 v17, v11, 6, v17
    v_lshl_add_u32 v17, v12, 3, v17
    s_lshl_b32 s26, s25, 11
    v_add_u32 v17, s26, v17
    s_waitcnt lgkmcnt(0)
    v_lshlrev_b32 v20, 16, v96
    v_and_b32 v21, 0xffff0000, v96
    v_mul_f32 v20, v20, v7
    v_mul_f32 v21, v21, v7
    v_cvt_pk_bf16_f32 v22, v20, v21
    v_cvt_pk_bf16_f32 v23, v64, v65
    v_lshlrev_b32 v20, 16, v22
    v_and_b32 v21, 0xffff0000, v22
    v_lshlrev_b32 v24, 16, v23
    v_and_b32 v25, 0xffff0000, v23
    v_add_f32 v20, v20, v24
    v_add_f32 v21, v21, v25
    v_cvt_pk_bf16_f32 v26, v20, v21
    v_lshlrev_b32 v20, 16, v97
    v_and_b32 v21, 0xffff0000, v97
    v_mul_f32 v20, v20, v7
    v_mul_f32 v21, v21, v7
    v_cvt_pk_bf16_f32 v22, v20, v21
    v_cvt_pk_bf16_f32 v23, v66, v67
    v_lshlrev_b32 v20, 16, v22
    v_and_b32 v21, 0xffff0000, v22
    v_lshlrev_b32 v24, 16, v23
    v_and_b32 v25, 0xffff0000, v23
    v_add_f32 v20, v20, v24
    v_add_f32 v21, v21, v25
    v_cvt_pk_bf16_f32 v27, v20, v21
    buffer_store_dwordx2 v[26:27], v17, s[16:19], 0 offen offset:0 sc1
    v_lshlrev_b32 v20, 16, v98
    v_and_b32 v21, 0xffff0000, v98
    v_mul_f32 v20, v20, v7
    v_mul_f32 v21, v21, v7
    v_cvt_pk_bf16_f32 v22, v20, v21
    v_cvt_pk_bf16_f32 v23, v68, v69
    v_lshlrev_b32 v20, 16, v22
    v_and_b32 v21, 0xffff0000, v22
    v_lshlrev_b32 v24, 16, v23
    v_and_b32 v25, 0xffff0000, v23
    v_add_f32 v20, v20, v24
    v_add_f32 v21, v21, v25
    v_cvt_pk_bf16_f32 v28, v20, v21
    v_lshlrev_b32 v20, 16, v99
    v_and_b32 v21, 0xffff0000, v99
    v_mul_f32 v20, v20, v7
    v_mul_f32 v21, v21, v7
    v_cvt_pk_bf16_f32 v22, v20, v21
    v_cvt_pk_bf16_f32 v23, v70, v71
    v_lshlrev_b32 v20, 16, v22
    v_and_b32 v21, 0xffff0000, v22
    v_lshlrev_b32 v24, 16, v23
    v_and_b32 v25, 0xffff0000, v23
    v_add_f32 v20, v20, v24
    v_add_f32 v21, v21, v25
    v_cvt_pk_bf16_f32 v29, v20, v21
    buffer_store_dwordx2 v[28:29], v17, s[16:19], 0 offen offset:16 sc1
    v_lshlrev_b32 v20, 16, v100
    v_and_b32 v21, 0xffff0000, v100
    v_mul_f32 v20, v20, v7
    v_mul_f32 v21, v21, v7
    v_cvt_pk_bf16_f32 v22, v20, v21
    v_cvt_pk_bf16_f32 v23, v72, v73
    v_lshlrev_b32 v20, 16, v22
    v_and_b32 v21, 0xffff0000, v22
    v_lshlrev_b32 v24, 16, v23
    v_and_b32 v25, 0xffff0000, v23
    v_add_f32 v20, v20, v24
    v_add_f32 v21, v21, v25
    v_cvt_pk_bf16_f32 v26, v20, v21
    v_lshlrev_b32 v20, 16, v101
    v_and_b32 v21, 0xffff0000, v101
    v_mul_f32 v20, v20, v7
    v_mul_f32 v21, v21, v7
    v_cvt_pk_bf16_f32 v22, v20, v21
    v_cvt_pk_bf16_f32 v23, v74, v75
    v_lshlrev_b32 v20, 16, v22
    v_and_b32 v21, 0xffff0000, v22
    v_lshlrev_b32 v24, 16, v23
    v_and_b32 v25, 0xffff0000, v23
    v_add_f32 v20, v20, v24
    v_add_f32 v21, v21, v25
    v_cvt_pk_bf16_f32 v27, v20, v21
    buffer_store_dwordx2 v[26:27], v17, s[16:19], 0 offen offset:32 sc1
    v_lshlrev_b32 v20, 16, v102
    v_and_b32 v21, 0xffff0000, v102
    v_mul_f32 v20, v20, v7
    v_mul_f32 v21, v21, v7
    v_cvt_pk_bf16_f32 v22, v20, v21
    v_cvt_pk_bf16_f32 v23, v76, v77
    v_lshlrev_b32 v20, 16, v22
    v_and_b32 v21, 0xffff0000, v22
    v_lshlrev_b32 v24, 16, v23
    v_and_b32 v25, 0xffff0000, v23
    v_add_f32 v20, v20, v24
    v_add_f32 v21, v21, v25
    v_cvt_pk_bf16_f32 v28, v20, v21
    v_lshlrev_b32 v20, 16, v103
    v_and_b32 v21, 0xffff0000, v103
    v_mul_f32 v20, v20, v7
    v_mul_f32 v21, v21, v7
    v_cvt_pk_bf16_f32 v22, v20, v21
    v_cvt_pk_bf16_f32 v23, v78, v79
    v_lshlrev_b32 v20, 16, v22
    v_and_b32 v21, 0xffff0000, v22
    v_lshlrev_b32 v24, 16, v23
    v_and_b32 v25, 0xffff0000, v23
    v_add_f32 v20, v20, v24
    v_add_f32 v21, v21, v25
    v_cvt_pk_bf16_f32 v29, v20, v21
    buffer_store_dwordx2 v[28:29], v17, s[16:19], 0 offen offset:48 sc1
    s_waitcnt vmcnt(0)
    s_barrier
    s_add_u32 s52, s6, 18890752
    s_addc_u32 s53, s7, 0
    s_mov_b32 s54, 4096
    s_mov_b32 s55, 0x00020000
    s_lshr_b32 s26, s3, 5
    s_lshl_b32 s26, s26, 8
    v_mov_b32 v20, s26
    v_mov_b32 v21, 1
    v_cmp_eq_u32 vcc, 0, v0
    s_and_saveexec_b64 s[26:27], vcc
    buffer_atomic_add v21, v20, s[52:55], 0 offen
    s_mov_b64 exec, s[26:27]
    s_endpgm
kb_kernel_exit:
    s_endpgm
.section .rodata,"a"
.p2align 6
.amdhsa_kernel ka_kernel
  .amdhsa_next_free_vgpr 128
  .amdhsa_next_free_sgpr 102
  .amdhsa_accum_offset 128
  .amdhsa_group_segment_fixed_size 0
  .amdhsa_kernarg_size 104
  .amdhsa_user_sgpr_count 2
  .amdhsa_user_sgpr_kernarg_segment_ptr 1
  .amdhsa_system_sgpr_workgroup_id_x 1
  .amdhsa_float_denorm_mode_32 3
  .amdhsa_float_denorm_mode_16_64 3
.end_amdhsa_kernel
.amdhsa_kernel kb_kernel
  .amdhsa_next_free_vgpr 168
  .amdhsa_next_free_sgpr 102
  .amdhsa_accum_offset 168
  .amdhsa_group_segment_fixed_size 0
  .amdhsa_kernarg_size 104
  .amdhsa_user_sgpr_count 2
  .amdhsa_user_sgpr_kernarg_segment_ptr 1
  .amdhsa_system_sgpr_workgroup_id_x 1
  .amdhsa_float_denorm_mode_32 3
  .amdhsa_float_denorm_mode_16_64 3
.end_amdhsa_kernel
```
